```python
import torch

def _softmax(x, axis=-1):
    return torch.softmax(x, dim=axis)
def _gelu(x):
    return torch.nn.functional.gelu(x, approximate="tanh")
def _silu(x):
    return torch.nn.functional.silu(x)
def _sigmoid(x):
    return torch.sigmoid(x)
def _layernorm(x, axis=-1, eps=1e-5):
    m = x.mean(dim=axis, keepdim=True)
    v = x.var(dim=axis, keepdim=True, unbiased=False)
    return (x - m) / torch.sqrt(v + eps)
def _scatter_add(tgt, idx, src, axis=0):
    return tgt.clone().index_add_(axis, idx, src)
def _segment_sum(src, seg, n):
    out = torch.zeros((n,) + src.shape[1:], dtype=src.dtype)
    return out.index_add_(0, seg, src)
def _pad(x, pw):
    flat = tuple(v for pair in reversed(pw) for v in pair)
    return torch.nn.functional.pad(x, flat)

kernel_name = 'gated_mix__softmax_full_mha__grouped_kv_mqa__prompt'

def setup_inputs():

    _w = (lambda a: (lambda t: t.to(torch.bfloat16) if t.is_floating_point() else t)(torch.as_tensor(a)))
    def _A_setup():
        B, S, D = 1, 2048, 576
        return {
            "x": _w((lambda *s: torch.randn(*s, dtype=torch.bfloat16) * 0.1)(B, S, D)),
            "wqkv": _w((lambda *s: torch.randn(*s, dtype=torch.bfloat16) * 0.4)(D, 3 * D)),
            "wo": _w((lambda *s: torch.randn(*s, dtype=torch.bfloat16) * 0.2)(D, D)),
        }
    _A_in = _A_setup()

    def _B_setup():
        B, S, D, H = 1, 2048, 576, 32
        Dh = D // H
        return {
            "x": _w((lambda *s: torch.randn(*s, dtype=torch.bfloat16) * 0.1)(B, S, D)),
            "wq": _w((lambda *s: torch.randn(*s, dtype=torch.bfloat16) * 0.4)(D, H * Dh)),
            "wk": _w((lambda *s: torch.randn(*s, dtype=torch.bfloat16) * 0.4)(D, Dh)),
            "wv": _w((lambda *s: torch.randn(*s, dtype=torch.bfloat16) * 0.4)(D, Dh)),
            "wo": _w((lambda *s: torch.randn(*s, dtype=torch.bfloat16) * 0.4)(H * Dh, D)),
        }
    _B_in = _B_setup()

    return {
        "A_x": _A_in["x"],
        "A_wqkv": _A_in["wqkv"],
        "A_wo": _A_in["wo"],
        "B_x": _B_in["x"],
        "B_wq": _B_in["wq"],
        "B_wk": _B_in["wk"],
        "B_wv": _B_in["wv"],
        "B_wo": _B_in["wo"],
        "gate_w": _w((lambda *s: torch.randn(*s, dtype=torch.bfloat16) * 0.1)(576) * 16.0),
    }

def reference(A_x, A_wqkv, A_wo, B_x, B_wq, B_wk, B_wv, B_wo, gate_w):
    def _A_ref(x, wqkv, wo):
        B, S, D = x.shape
        H = 32; Dh = D // H
        qkv = (lambda x, *d: x.permute(*d))((x @ wqkv).reshape(B, S, 3, H, Dh), 2, 0, 3, 1, 4)
        q, k, v = qkv[0], qkv[1], qkv[2]
        scale = Dh ** -0.5
        scores = torch.einsum("bhqd,bhkd->bhqk", q, k) * scale
        p = _softmax(scores, axis=-1)
        o = torch.einsum("bhqk,bhkd->bhqd", p, v)
        return (lambda x, *d: x.permute(*d))(o, 0, 2, 1, 3).reshape(B, S, D) @ wo

    def _B_ref(x, wq, wk, wv, wo):
        B, S, D = x.shape
        H = 32
        Dh = D // H
        q = (lambda x, *d: x.permute(*d))((x @ wq).reshape(B, S, H, Dh), 0, 2, 1, 3)
        k = x @ wk
        v = x @ wv
        scores = torch.einsum("bhqd,bkd->bhqk", q, k) * (Dh ** -0.5)
        p = _softmax(scores, axis=-1)
        o = torch.einsum("bhqk,bkd->bhqd", p, v)
        return (lambda x, *d: x.permute(*d))(o, 0, 2, 1, 3).reshape(B, S, H * Dh) @ wo

    x = A_x
    g = _sigmoid((x * gate_w).sum(-1, keepdims=True))
    a = _A_ref(x, A_wqkv, A_wo)
    b = _B_ref(x, B_wq, B_wk, B_wv, B_wo)
    return g * a + (1 - g) * b
```

```asm
; @launch grid=(256,1,1) block=(512,1,1) lds=163840
.amdgcn_target "amdgcn-amd-amdhsa--gfx950"
.text
.globl gated_mix__softmax_full_mha__grouped_kv_mqa__prompt_kernel
.p2align 8
.type gated_mix__softmax_full_mha__grouped_kv_mqa__prompt_kernel,@function
gated_mix__softmax_full_mha__grouped_kv_mqa__prompt_kernel:
    s_cmp_ge_u32 s2, 256
    s_cbranch_scc1 K2_END
    s_load_dwordx4 s[4:7], s[0:1], 0
    s_load_dwordx4 s[8:11], s[0:1], 32
    s_load_dwordx2 s[12:13], s[0:1], 48
    s_load_dwordx2 s[14:15], s[0:1], 64
    s_load_dwordx2 s[16:17], s[0:1], 88
    s_load_dwordx2 s[60:61], s[0:1], 80
    s_getpc_b64 s[20:21]
K1_PC:
    s_lshr_b32 s19, s2, 3
    s_lshl_b32 s19, s19, 11
    v_lshrrev_b32 v1, 5, v0
    v_lshlrev_b32 v1, 7, v1
    v_add_u32 v1, s19, v1
    v_min_u32 v1, CODE_END-K1_PC-4, v1
    global_load_dword v29, v1, s[20:21]
    v_lshrrev_b32 v1, 6, v0
    v_and_b32 v0, 63, v0
    s_and_b32 s18, s2, 7
    v_readfirstlane_b32 s3, v1
    s_lshr_b32 s19, s2, 3
    s_cmp_ge_u32 s18, 4
    s_cbranch_scc1 K1_DEC1
    s_mul_i32 s28, s18, 31
    s_add_u32 s29, s18, 1
    s_lshr_b32 s29, s29, 1
    s_add_u32 s28, s28, s29
    s_add_u32 s28, s28, s19
    s_and_b32 s18, s18, 1
    s_add_u32 s19, s19, s18
    s_mul_i32 s29, s28, 9363
    s_lshr_b32 s29, s29, 16
    s_mul_i32 s30, s29, 7
    s_sub_u32 s28, s28, s30
    s_cmp_eq_u32 s19, 32
    s_cselect_b32 s29, 19, s29
    s_branch K1_DEC2
K1_DEC1:
    s_sub_u32 s18, s18, 4
    s_mul_i32 s28, s18, 27
    s_add_u32 s28, s28, s19
    s_mul_i32 s29, s28, 10923
    s_lshr_b32 s29, s29, 16
    s_mul_i32 s30, s29, 6
    s_sub_u32 s28, s28, s30
    s_add_u32 s28, s28, 7
    s_cmp_lt_u32 s19, 27
    s_cbranch_scc1 K1_DEC2
    s_sub_u32 s28, s19, 27
    s_lshl_b32 s28, s28, 2
    s_add_u32 s28, s28, s18
    s_mov_b32 s29, 18
K1_DEC2:
    s_mul_i32 s18, s29, 13
    s_add_u32 s18, s18, s28
K1_DEC:
    s_mov_b32 s69, s3
    s_cmp_ge_u32 s3, 4
    s_cbranch_scc1 K1_COMPUTE
    s_load_dwordx2 s[56:57], s[0:1], 16
    s_load_dwordx2 s[58:59], s[0:1], 56
    s_mul_i32 s54, s28, 0xffff7000
    s_add_u32 s54, s54, 1327104
    s_mul_i32 s30, s28, 96
    s_lshl_b32 s31, s3, 3
    s_add_u32 s30, s30, s31
    v_lshrrev_b32 v4, 3, v0
    v_add_u32 v4, s30, v4
    v_mul_u32_u24 v4, 1152, v4
    v_and_b32 v5, 7, v0
    v_lshrrev_b32 v6, 4, v0
    s_and_b32 s31, s3, 1
    s_lshl_b32 s31, s31, 2
    v_xor_b32 v5, v5, v6
    v_xor_b32 v5, s31, v5
    v_lshl_add_u32 v8, v5, 4, v4
    s_mul_i32 s53, s28, 1
    s_mul_i32 s30, s29, 1
    s_add_u32 s53, s53, s30
    s_mul_i32 s30, s53, 7282
    s_lshr_b32 s30, s30, 16
    s_mul_i32 s30, s30, 9
    s_sub_u32 s53, s53, s30
    v_and_b32 v5, 15, v0
    v_lshlrev_b32 v7, 2, v6
    v_xor_b32 v5, v5, v7
    s_lshl_b32 s31, s3, 4
    s_lshl_b32 s30, s53, 6
    s_add_u32 s31, s31, s30
    v_add_u32 v6, s31, v6
    s_lshl_b32 s53, s53, 7
    s_lshl_b32 s50, s3, 12
    s_lshl_b32 s51, s3, 10
    s_cmp_eq_u32 s29, 18
    s_cbranch_scc1 K1_LEXT
    s_lshl_b32 s30, s29, 4
    v_add_u32 v5, s30, v5
    v_cmp_gt_u32 vcc, 216, v5
    v_subrev_u32 v7, 216, v5
    v_mov_b32 v9, 1152
    v_mov_b32 v10, 3456
    v_cndmask_b32 v5, v7, v5, vcc
    v_cndmask_b32 v14, v9, v10, vcc
    v_lshlrev_b32 v5, 4, v5
    s_waitcnt lgkmcnt(0)
    s_mov_b64 s[44:45], s[8:9]
    s_mov_b64 s[46:47], s[6:7]
    s_branch K1_LCOM
K1_LEXT:
    v_and_b32 v7, 4, v5
    v_cmp_eq_u32 vcc, 0, v7
    v_bfe_u32 v7, v5, 1, 1
    v_and_b32 v5, 1, v5
    v_lshlrev_b32 v5, 4, v5
    v_lshl_add_u32 v5, v7, 2, v5
    v_mov_b32 v14, 36
    s_waitcnt lgkmcnt(0)
    s_mov_b64 s[44:45], s[12:13]
    s_mov_b64 s[46:47], s[10:11]
K1_LCOM:
    s_mov_b32 s20, s4
    s_mov_b32 s21, s5
    s_mov_b32 s22, 2359296
    s_mov_b32 s23, 0x00020000
    s_cmp_ge_u32 s18, 247
    s_cbranch_scc1 K1_GATE0
    v_mov_b32 v9, s44
    v_mov_b32 v10, s46
    v_cndmask_b32 v12, v9, v10, vcc
    v_mov_b32 v9, s45
    v_mov_b32 v10, s47
    v_cndmask_b32 v13, v9, v10, vcc
    v_mad_u32_u24 v5, v6, v14, v5
    v_add_co_u32 v12, vcc, v12, v5
    v_lshlrev_b32 v15, 2, v14
    v_mul_u32_u24 v16, 52, v14
    v_addc_co_u32 v13, vcc, 0, v13, vcc
    v_mul_u32_u24 v17, 576, v14
    s_add_u32 m0, s51, 16384
    s_add_u32 s52, s53, 0
    buffer_load_dwordx4 v8, s[20:23], s52 offen lds
    s_add_u32 m0, s51, 20480
    s_add_u32 s52, s53, 36864
    buffer_load_dwordx4 v8, s[20:23], s52 offen lds
    s_add_u32 m0, s50, 0
    s_nop 0
    global_load_lds_dwordx4 v[12:13], off
    v_add_co_u32 v12, vcc, v15, v12
    s_nop 1
    v_addc_co_u32 v13, vcc, 0, v13, vcc
    s_add_u32 m0, s50, 1024
    s_nop 0
    global_load_lds_dwordx4 v[12:13], off
    v_add_co_u32 v12, vcc, v15, v12
    s_nop 1
    v_addc_co_u32 v13, vcc, 0, v13, vcc
    s_add_u32 m0, s50, 2048
    s_nop 0
    global_load_lds_dwordx4 v[12:13], off
    v_add_co_u32 v12, vcc, v15, v12
    s_nop 1
    v_addc_co_u32 v13, vcc, 0, v13, vcc
    s_add_u32 m0, s50, 3072
    s_nop 0
    global_load_lds_dwordx4 v[12:13], off
    v_add_co_u32 v12, vcc, v16, v12
    s_nop 1
    v_addc_co_u32 v13, vcc, 0, v13, vcc
    s_add_u32 s53, s53, 128
    s_cmp_eq_u32 s53, 1152
    s_cselect_b32 s53, 0, s53
    s_cbranch_scc0 K1_NW0
    v_sub_co_u32 v12, vcc, v12, v17
    s_nop 1
    v_subbrev_co_u32 v13, vcc, 0, v13, vcc
K1_NW0:
    s_add_u32 m0, s51, 40960
    s_add_u32 s52, s53, 0
    buffer_load_dwordx4 v8, s[20:23], s52 offen lds
    s_add_u32 m0, s51, 45056
    s_add_u32 s52, s53, 36864
    buffer_load_dwordx4 v8, s[20:23], s52 offen lds
    s_add_u32 m0, s50, 24576
    s_nop 0
    global_load_lds_dwordx4 v[12:13], off
    v_add_co_u32 v12, vcc, v15, v12
    s_nop 1
    v_addc_co_u32 v13, vcc, 0, v13, vcc
    s_add_u32 m0, s50, 25600
    s_nop 0
    global_load_lds_dwordx4 v[12:13], off
    v_add_co_u32 v12, vcc, v15, v12
    s_nop 1
    v_addc_co_u32 v13, vcc, 0, v13, vcc
    s_add_u32 m0, s50, 26624
    s_nop 0
    global_load_lds_dwordx4 v[12:13], off
    v_add_co_u32 v12, vcc, v15, v12
    s_nop 1
    v_addc_co_u32 v13, vcc, 0, v13, vcc
    s_add_u32 m0, s50, 27648
    s_nop 0
    global_load_lds_dwordx4 v[12:13], off
    v_add_co_u32 v12, vcc, v16, v12
    s_nop 1
    v_addc_co_u32 v13, vcc, 0, v13, vcc
    s_add_u32 s53, s53, 128
    s_cmp_eq_u32 s53, 1152
    s_cselect_b32 s53, 0, s53
    s_cbranch_scc0 K1_NW1
    v_sub_co_u32 v12, vcc, v12, v17
    s_nop 1
    v_subbrev_co_u32 v13, vcc, 0, v13, vcc
K1_NW1:
    s_add_u32 m0, s51, 65536
    s_add_u32 s52, s53, 0
    buffer_load_dwordx4 v8, s[20:23], s52 offen lds
    s_add_u32 m0, s51, 69632
    s_add_u32 s52, s53, 36864
    buffer_load_dwordx4 v8, s[20:23], s52 offen lds
    s_add_u32 m0, s50, 49152
    s_nop 0
    global_load_lds_dwordx4 v[12:13], off
    v_add_co_u32 v12, vcc, v15, v12
    s_nop 1
    v_addc_co_u32 v13, vcc, 0, v13, vcc
    s_add_u32 m0, s50, 50176
    s_nop 0
    global_load_lds_dwordx4 v[12:13], off
    v_add_co_u32 v12, vcc, v15, v12
    s_nop 1
    v_addc_co_u32 v13, vcc, 0, v13, vcc
    s_add_u32 m0, s50, 51200
    s_nop 0
    global_load_lds_dwordx4 v[12:13], off
    v_add_co_u32 v12, vcc, v15, v12
    s_nop 1
    v_addc_co_u32 v13, vcc, 0, v13, vcc
    s_add_u32 m0, s50, 52224
    s_nop 0
    global_load_lds_dwordx4 v[12:13], off
    v_add_co_u32 v12, vcc, v16, v12
    s_nop 1
    v_addc_co_u32 v13, vcc, 0, v13, vcc
    s_add_u32 s53, s53, 128
    s_cmp_eq_u32 s53, 1152
    s_cselect_b32 s53, 0, s53
    s_cbranch_scc0 K1_NW2
    v_sub_co_u32 v12, vcc, v12, v17
    s_nop 1
    v_subbrev_co_u32 v13, vcc, 0, v13, vcc
K1_NW2:
    s_waitcnt vmcnt(12)
    s_barrier
    s_add_u32 m0, s51, 90112
    s_add_u32 s52, s53, 0
    buffer_load_dwordx4 v8, s[20:23], s52 offen lds
    s_add_u32 m0, s51, 94208
    s_add_u32 s52, s53, 36864
    buffer_load_dwordx4 v8, s[20:23], s52 offen lds
    s_add_u32 m0, s50, 73728
    s_nop 0
    global_load_lds_dwordx4 v[12:13], off
    v_add_co_u32 v12, vcc, v15, v12
    s_nop 1
    v_addc_co_u32 v13, vcc, 0, v13, vcc
    s_add_u32 m0, s50, 74752
    s_nop 0
    global_load_lds_dwordx4 v[12:13], off
    v_add_co_u32 v12, vcc, v15, v12
    s_nop 1
    v_addc_co_u32 v13, vcc, 0, v13, vcc
    s_add_u32 m0, s50, 75776
    s_nop 0
    global_load_lds_dwordx4 v[12:13], off
    v_add_co_u32 v12, vcc, v15, v12
    s_nop 1
    v_addc_co_u32 v13, vcc, 0, v13, vcc
    s_add_u32 m0, s50, 76800
    s_nop 0
    global_load_lds_dwordx4 v[12:13], off
    v_add_co_u32 v12, vcc, v16, v12
    s_nop 1
    v_addc_co_u32 v13, vcc, 0, v13, vcc
    s_add_u32 s53, s53, 128
    s_cmp_eq_u32 s53, 1152
    s_cselect_b32 s53, 0, s53
    s_cbranch_scc0 K1_NW3
    v_sub_co_u32 v12, vcc, v12, v17
    s_nop 1
    v_subbrev_co_u32 v13, vcc, 0, v13, vcc
K1_NW3:
    s_waitcnt vmcnt(12)
    s_barrier
    s_add_u32 m0, s51, 114688
    s_add_u32 s52, s53, 0
    buffer_load_dwordx4 v8, s[20:23], s52 offen lds
    s_add_u32 m0, s51, 118784
    s_add_u32 s52, s53, 36864
    buffer_load_dwordx4 v8, s[20:23], s52 offen lds
    s_add_u32 m0, s50, 98304
    s_nop 0
    global_load_lds_dwordx4 v[12:13], off
    v_add_co_u32 v12, vcc, v15, v12
    s_nop 1
    v_addc_co_u32 v13, vcc, 0, v13, vcc
    s_add_u32 m0, s50, 99328
    s_nop 0
    global_load_lds_dwordx4 v[12:13], off
    v_add_co_u32 v12, vcc, v15, v12
    s_nop 1
    v_addc_co_u32 v13, vcc, 0, v13, vcc
    s_add_u32 m0, s50, 100352
    s_nop 0
    global_load_lds_dwordx4 v[12:13], off
    v_add_co_u32 v12, vcc, v15, v12
    s_nop 1
    v_addc_co_u32 v13, vcc, 0, v13, vcc
    s_add_u32 m0, s50, 101376
    s_nop 0
    global_load_lds_dwordx4 v[12:13], off
    v_add_co_u32 v12, vcc, v16, v12
    s_nop 1
    v_addc_co_u32 v13, vcc, 0, v13, vcc
    s_add_u32 s53, s53, 128
    s_cmp_eq_u32 s53, 1152
    s_cselect_b32 s53, 0, s53
    s_cbranch_scc0 K1_NW4
    v_sub_co_u32 v12, vcc, v12, v17
    s_nop 1
    v_subbrev_co_u32 v13, vcc, 0, v13, vcc
K1_NW4:
    s_waitcnt vmcnt(12)
    s_barrier
    s_add_u32 m0, s51, 139264
    s_add_u32 s52, s53, 0
    buffer_load_dwordx4 v8, s[20:23], s52 offen lds
    s_add_u32 m0, s51, 143360
    s_add_u32 s52, s53, 36864
    buffer_load_dwordx4 v8, s[20:23], s52 offen lds
    s_add_u32 m0, s50, 122880
    s_nop 0
    global_load_lds_dwordx4 v[12:13], off
    v_add_co_u32 v12, vcc, v15, v12
    s_nop 1
    v_addc_co_u32 v13, vcc, 0, v13, vcc
    s_add_u32 m0, s50, 123904
    s_nop 0
    global_load_lds_dwordx4 v[12:13], off
    v_add_co_u32 v12, vcc, v15, v12
    s_nop 1
    v_addc_co_u32 v13, vcc, 0, v13, vcc
    s_add_u32 m0, s50, 124928
    s_nop 0
    global_load_lds_dwordx4 v[12:13], off
    v_add_co_u32 v12, vcc, v15, v12
    s_nop 1
    v_addc_co_u32 v13, vcc, 0, v13, vcc
    s_add_u32 m0, s50, 125952
    s_nop 0
    global_load_lds_dwordx4 v[12:13], off
    v_add_co_u32 v12, vcc, v16, v12
    s_nop 1
    v_addc_co_u32 v13, vcc, 0, v13, vcc
    s_add_u32 s53, s53, 128
    s_cmp_eq_u32 s53, 1152
    s_cselect_b32 s53, 0, s53
    s_cbranch_scc0 K1_NW5
    v_sub_co_u32 v12, vcc, v12, v17
    s_nop 1
    v_subbrev_co_u32 v13, vcc, 0, v13, vcc
K1_NW5:
    s_waitcnt vmcnt(12)
    s_barrier
    s_add_u32 m0, s51, 16384
    s_add_u32 s52, s53, 0
    buffer_load_dwordx4 v8, s[20:23], s52 offen lds
    s_add_u32 m0, s51, 20480
    s_add_u32 s52, s53, 36864
    buffer_load_dwordx4 v8, s[20:23], s52 offen lds
    s_add_u32 m0, s50, 0
    s_nop 0
    global_load_lds_dwordx4 v[12:13], off
    v_add_co_u32 v12, vcc, v15, v12
    s_nop 1
    v_addc_co_u32 v13, vcc, 0, v13, vcc
    s_add_u32 m0, s50, 1024
    s_nop 0
    global_load_lds_dwordx4 v[12:13], off
    v_add_co_u32 v12, vcc, v15, v12
    s_nop 1
    v_addc_co_u32 v13, vcc, 0, v13, vcc
    s_add_u32 m0, s50, 2048
    s_nop 0
    global_load_lds_dwordx4 v[12:13], off
    v_add_co_u32 v12, vcc, v15, v12
    s_nop 1
    v_addc_co_u32 v13, vcc, 0, v13, vcc
    s_add_u32 m0, s50, 3072
    s_nop 0
    global_load_lds_dwordx4 v[12:13], off
    v_add_co_u32 v12, vcc, v16, v12
    s_nop 1
    v_addc_co_u32 v13, vcc, 0, v13, vcc
    s_add_u32 s53, s53, 128
    s_cmp_eq_u32 s53, 1152
    s_cselect_b32 s53, 0, s53
    s_cbranch_scc0 K1_NW6
    v_sub_co_u32 v12, vcc, v12, v17
    s_nop 1
    v_subbrev_co_u32 v13, vcc, 0, v13, vcc
K1_NW6:
    s_waitcnt vmcnt(12)
    s_barrier
    s_add_u32 m0, s51, 40960
    s_add_u32 s52, s53, 0
    buffer_load_dwordx4 v8, s[20:23], s52 offen lds
    s_add_u32 m0, s51, 45056
    s_add_u32 s52, s53, 36864
    buffer_load_dwordx4 v8, s[20:23], s52 offen lds
    s_add_u32 m0, s50, 24576
    s_nop 0
    global_load_lds_dwordx4 v[12:13], off
    v_add_co_u32 v12, vcc, v15, v12
    s_nop 1
    v_addc_co_u32 v13, vcc, 0, v13, vcc
    s_add_u32 m0, s50, 25600
    s_nop 0
    global_load_lds_dwordx4 v[12:13], off
    v_add_co_u32 v12, vcc, v15, v12
    s_nop 1
    v_addc_co_u32 v13, vcc, 0, v13, vcc
    s_add_u32 m0, s50, 26624
    s_nop 0
    global_load_lds_dwordx4 v[12:13], off
    v_add_co_u32 v12, vcc, v15, v12
    s_nop 1
    v_addc_co_u32 v13, vcc, 0, v13, vcc
    s_add_u32 m0, s50, 27648
    s_nop 0
    global_load_lds_dwordx4 v[12:13], off
    v_add_co_u32 v12, vcc, v16, v12
    s_nop 1
    v_addc_co_u32 v13, vcc, 0, v13, vcc
    s_add_u32 s53, s53, 128
    s_cmp_eq_u32 s53, 1152
    s_cselect_b32 s53, 0, s53
    s_cbranch_scc0 K1_NW7
    v_sub_co_u32 v12, vcc, v12, v17
    s_nop 1
    v_subbrev_co_u32 v13, vcc, 0, v13, vcc
K1_NW7:
    s_waitcnt vmcnt(12)
    s_barrier
    s_add_u32 m0, s51, 65536
    s_add_u32 s52, s53, 0
    buffer_load_dwordx4 v8, s[20:23], s52 offen lds
    s_add_u32 m0, s51, 69632
    s_add_u32 s52, s53, 36864
    buffer_load_dwordx4 v8, s[20:23], s52 offen lds
    s_add_u32 m0, s50, 49152
    s_nop 0
    global_load_lds_dwordx4 v[12:13], off
    v_add_co_u32 v12, vcc, v15, v12
    s_nop 1
    v_addc_co_u32 v13, vcc, 0, v13, vcc
    s_add_u32 m0, s50, 50176
    s_nop 0
    global_load_lds_dwordx4 v[12:13], off
    v_add_co_u32 v12, vcc, v15, v12
    s_nop 1
    v_addc_co_u32 v13, vcc, 0, v13, vcc
    s_add_u32 m0, s50, 51200
    s_nop 0
    global_load_lds_dwordx4 v[12:13], off
    v_add_co_u32 v12, vcc, v15, v12
    s_nop 1
    v_addc_co_u32 v13, vcc, 0, v13, vcc
    s_add_u32 m0, s50, 52224
    s_nop 0
    global_load_lds_dwordx4 v[12:13], off
    v_add_co_u32 v12, vcc, v16, v12
    s_nop 1
    v_addc_co_u32 v13, vcc, 0, v13, vcc
    s_add_u32 s53, s53, 128
    s_cmp_eq_u32 s53, 1152
    s_cselect_b32 s53, 0, s53
    s_waitcnt vmcnt(12)
    s_barrier
    s_add_u32 m0, s51, 73728
    s_add_u32 s52, s53, 73728
    buffer_load_dwordx4 v8, s[20:23], s52 offen lds
    s_add_u32 s53, s53, 128
    s_cmp_eq_u32 s53, 1152
    s_cselect_b32 s53, 0, s53
    s_add_u32 m0, s51, 77824
    s_add_u32 s52, s53, 73728
    buffer_load_dwordx4 v8, s[20:23], s52 offen lds
    s_add_u32 s53, s53, 128
    s_cmp_eq_u32 s53, 1152
    s_cselect_b32 s53, 0, s53
    s_add_u32 m0, s51, 81920
    s_add_u32 s52, s53, 73728
    buffer_load_dwordx4 v8, s[20:23], s52 offen lds
    s_add_u32 s53, s53, 128
    s_cmp_eq_u32 s53, 1152
    s_cselect_b32 s53, 0, s53
    s_add_u32 m0, s51, 86016
    s_add_u32 s52, s53, 73728
    buffer_load_dwordx4 v8, s[20:23], s52 offen lds
    s_add_u32 s53, s53, 128
    s_cmp_eq_u32 s53, 1152
    s_cselect_b32 s53, 0, s53
    s_add_u32 m0, s51, 90112
    s_add_u32 s52, s53, 73728
    buffer_load_dwordx4 v8, s[20:23], s52 offen lds
    s_add_u32 s53, s53, 128
    s_cmp_eq_u32 s53, 1152
    s_cselect_b32 s53, 0, s53
    s_add_u32 m0, s51, 94208
    s_add_u32 s52, s53, 73728
    buffer_load_dwordx4 v8, s[20:23], s52 offen lds
    s_add_u32 s53, s53, 128
    s_cmp_eq_u32 s53, 1152
    s_cselect_b32 s53, 0, s53
    s_waitcnt vmcnt(12)
    s_barrier
    s_add_u32 m0, s51, 98304
    s_add_u32 s52, s53, 73728
    buffer_load_dwordx4 v8, s[20:23], s52 offen lds
    s_add_u32 s53, s53, 128
    s_cmp_eq_u32 s53, 1152
    s_cselect_b32 s53, 0, s53
    s_add_u32 m0, s51, 102400
    s_add_u32 s52, s53, 73728
    buffer_load_dwordx4 v8, s[20:23], s52 offen lds
    s_add_u32 s53, s53, 128
    s_cmp_eq_u32 s53, 1152
    s_cselect_b32 s53, 0, s53
    s_add_u32 m0, s51, 106496
    s_add_u32 s52, s53, 73728
    buffer_load_dwordx4 v8, s[20:23], s52 offen lds
    s_add_u32 s53, s53, 128
    s_cmp_eq_u32 s53, 1152
    s_cselect_b32 s53, 0, s53
    s_add_u32 m0, s51, 110592
    s_add_u32 s52, s53, 110592
    s_add_u32 s52, s52, s54
    buffer_load_dwordx4 v8, s[20:23], s52 offen lds
    s_add_u32 s53, s53, 128
    s_cmp_eq_u32 s53, 1152
    s_cselect_b32 s53, 0, s53
    s_add_u32 m0, s51, 114688
    s_add_u32 s52, s53, 110592
    s_add_u32 s52, s52, s54
    buffer_load_dwordx4 v8, s[20:23], s52 offen lds
    s_add_u32 s53, s53, 128
    s_cmp_eq_u32 s53, 1152
    s_cselect_b32 s53, 0, s53
    s_add_u32 m0, s51, 118784
    s_add_u32 s52, s53, 110592
    s_add_u32 s52, s52, s54
    buffer_load_dwordx4 v8, s[20:23], s52 offen lds
    s_add_u32 s53, s53, 128
    s_cmp_eq_u32 s53, 1152
    s_cselect_b32 s53, 0, s53
    s_waitcnt vmcnt(12)
    s_barrier
    s_add_u32 m0, s51, 122880
    s_add_u32 s52, s53, 110592
    s_add_u32 s52, s52, s54
    buffer_load_dwordx4 v8, s[20:23], s52 offen lds
    s_add_u32 s53, s53, 128
    s_cmp_eq_u32 s53, 1152
    s_cselect_b32 s53, 0, s53
    s_add_u32 m0, s51, 126976
    s_add_u32 s52, s53, 110592
    s_add_u32 s52, s52, s54
    buffer_load_dwordx4 v8, s[20:23], s52 offen lds
    s_add_u32 s53, s53, 128
    s_cmp_eq_u32 s53, 1152
    s_cselect_b32 s53, 0, s53
    s_add_u32 m0, s51, 131072
    s_add_u32 s52, s53, 110592
    s_add_u32 s52, s52, s54
    buffer_load_dwordx4 v8, s[20:23], s52 offen lds
    s_add_u32 s53, s53, 128
    s_cmp_eq_u32 s53, 1152
    s_cselect_b32 s53, 0, s53
    s_add_u32 m0, s51, 135168
    s_add_u32 s52, s53, 110592
    s_add_u32 s52, s52, s54
    buffer_load_dwordx4 v8, s[20:23], s52 offen lds
    s_add_u32 s53, s53, 128
    s_cmp_eq_u32 s53, 1152
    s_cselect_b32 s53, 0, s53
    s_add_u32 m0, s51, 139264
    s_add_u32 s52, s53, 110592
    s_add_u32 s52, s52, s54
    buffer_load_dwordx4 v8, s[20:23], s52 offen lds
    s_add_u32 s53, s53, 128
    s_cmp_eq_u32 s53, 1152
    s_cselect_b32 s53, 0, s53
    s_add_u32 m0, s51, 143360
    s_add_u32 s52, s53, 110592
    s_add_u32 s52, s52, s54
    buffer_load_dwordx4 v8, s[20:23], s52 offen lds
    s_add_u32 s53, s53, 128
    s_cmp_eq_u32 s53, 1152
    s_cselect_b32 s53, 0, s53
    s_waitcnt vmcnt(15)
    s_barrier
    s_add_u32 m0, s51, 0
    s_add_u32 s52, s53, 147456
    s_add_u32 s52, s52, s54
    buffer_load_dwordx4 v8, s[20:23], s52 offen lds
    s_add_u32 s53, s53, 128
    s_cmp_eq_u32 s53, 1152
    s_cselect_b32 s53, 0, s53
    s_add_u32 m0, s51, 4096
    s_add_u32 s52, s53, 147456
    s_add_u32 s52, s52, s54
    buffer_load_dwordx4 v8, s[20:23], s52 offen lds
    s_add_u32 s53, s53, 128
    s_cmp_eq_u32 s53, 1152
    s_cselect_b32 s53, 0, s53
    s_add_u32 m0, s51, 8192
    s_add_u32 s52, s53, 147456
    s_add_u32 s52, s52, s54
    buffer_load_dwordx4 v8, s[20:23], s52 offen lds
    s_add_u32 s53, s53, 128
    s_cmp_eq_u32 s53, 1152
    s_cselect_b32 s53, 0, s53
    s_waitcnt vmcnt(15)
    s_barrier
    s_add_u32 m0, s51, 12288
    s_add_u32 s52, s53, 147456
    s_add_u32 s52, s52, s54
    buffer_load_dwordx4 v8, s[20:23], s52 offen lds
    s_add_u32 s53, s53, 128
    s_cmp_eq_u32 s53, 1152
    s_cselect_b32 s53, 0, s53
    s_add_u32 m0, s51, 16384
    s_add_u32 s52, s53, 147456
    s_add_u32 s52, s52, s54
    buffer_load_dwordx4 v8, s[20:23], s52 offen lds
    s_add_u32 s53, s53, 128
    s_cmp_eq_u32 s53, 1152
    s_cselect_b32 s53, 0, s53
    s_add_u32 m0, s51, 20480
    s_add_u32 s52, s53, 147456
    s_add_u32 s52, s52, s54
    buffer_load_dwordx4 v8, s[20:23], s52 offen lds
    s_add_u32 s53, s53, 128
    s_cmp_eq_u32 s53, 1152
    s_cselect_b32 s53, 0, s53
    s_waitcnt vmcnt(15)
    s_barrier
    s_add_u32 m0, s51, 24576
    s_add_u32 s52, s53, 147456
    s_add_u32 s52, s52, s54
    buffer_load_dwordx4 v8, s[20:23], s52 offen lds
    s_add_u32 s53, s53, 128
    s_cmp_eq_u32 s53, 1152
    s_cselect_b32 s53, 0, s53
    s_add_u32 m0, s51, 28672
    s_add_u32 s52, s53, 147456
    s_add_u32 s52, s52, s54
    buffer_load_dwordx4 v8, s[20:23], s52 offen lds
    s_add_u32 s53, s53, 128
    s_cmp_eq_u32 s53, 1152
    s_cselect_b32 s53, 0, s53
    s_add_u32 m0, s51, 32768
    s_add_u32 s52, s53, 147456
    s_add_u32 s52, s52, s54
    buffer_load_dwordx4 v8, s[20:23], s52 offen lds
    s_add_u32 s53, s53, 128
    s_cmp_eq_u32 s53, 1152
    s_cselect_b32 s53, 0, s53
    s_mov_b32 s24, s14
    s_mov_b32 s25, s15
    s_mov_b32 s26, 1152
    s_mov_b32 s27, 0x00020000
    v_and_b32 v1, 31, v0
    v_lshrrev_b32 v2, 5, v0
    s_lshl_b32 s30, s2, 3
    s_lshl_b32 s31, s3, 1
    s_add_u32 s30, s30, s31
    v_add_u32 v3, s30, v2
    v_mul_u32_u24 v4, 1152, v3
    v_lshlrev_b32 v5, 4, v1
    v_add_u32 v4, v4, v5
    v_mov_b32 v6, 0x7ffffff0
    v_cmp_gt_u32 vcc, 8, v1
    buffer_load_dwordx4 v[40:43], v4, s[20:23], 0 offen
    buffer_load_dwordx4 v[44:47], v4, s[20:23], 0 offen offset:512
    v_cndmask_b32 v6, v6, v4, vcc
    buffer_load_dwordx4 v[52:55], v5, s[24:27], 0 offen
    buffer_load_dwordx4 v[48:51], v6, s[20:23], 0 offen offset:1024
    buffer_load_dwordx4 v[56:59], v5, s[24:27], 0 offen offset:512
    buffer_load_dwordx4 v[60:63], v5, s[24:27], 0 offen offset:1024
    s_mov_b32 s62, 256
    s_mov_b32 s63, 0x00020000
    v_mov_b32 v64, 128
    buffer_load_dword v65, v64, s[60:63], 0 offen sc1
    s_waitcnt vmcnt(16)
    s_barrier
    s_setprio 2
    s_lshl_b32 s66, s2, 2
    s_add_u32 s66, s66, s3
    s_min_u32 s66, s66, 647
    s_mul_i32 s67, s66, 3641
    s_lshr_b32 s67, s67, 16
    s_mul_i32 s68, s67, 18
    s_sub_u32 s68, s66, s68
    s_and_b32 s34, s67, 15
    s_mul_i32 s34, s34, 41472
    s_and_b32 s35, s67, 1
    s_mul_i32 s35, s35, 331776
    s_add_u32 s35, s35, 18432
    s_lshr_b32 s37, s67, 4
    s_bfe_u32 s36, s67, 0x10001
    s_cmp_lt_u32 s67, 32
    s_cselect_b32 s34, s34, s35
    s_cselect_b32 s35, s37, s36
    s_cselect_b64 vcc, -1, 0
    s_cmp_eq_u32 s35, 0
    s_cselect_b32 s44, s56, s58
    s_cselect_b32 s45, s57, s59
    s_mov_b32 s46, 663552
    s_mov_b32 s47, 0x00020000
    s_lshl_b32 s66, s68, 6
    s_add_u32 s34, s34, s66
    v_lshrrev_b32 v127, 4, v0
    v_lshrrev_b32 v128, 1, v127
    v_mul_u32_u24 v128, 18, v128
    v_and_b32 v129, 1, v127
    v_lshl_add_u32 v128, v129, 2, v128
    v_mul_u32_u24 v129, 72, v127
    v_cndmask_b32 v128, v129, v128, vcc
    v_mul_u32_u24 v128, 1152, v128
    v_and_b32 v127, 15, v0
    v_lshl_add_u32 v128, v127, 2, v128
    s_cmp_lt_u32 s67, 32
    s_mov_b32 s35, 0
    s_cselect_b32 s35, 0, s35
    s_add_u32 s35, s35, s34
    buffer_load_dword v32, v128, s[44:47], s35 offen
    s_cmp_lt_u32 s67, 32
    s_mov_b32 s35, 1152
    s_cselect_b32 s35, 1152, s35
    s_add_u32 s35, s35, s34
    buffer_load_dword v33, v128, s[44:47], s35 offen
    s_cmp_lt_u32 s67, 32
    s_mov_b32 s35, 20736
    s_cselect_b32 s35, 2304, s35
    s_add_u32 s35, s35, s34
    buffer_load_dword v34, v128, s[44:47], s35 offen
    s_cmp_lt_u32 s67, 32
    s_mov_b32 s35, 21888
    s_cselect_b32 s35, 3456, s35
    s_add_u32 s35, s35, s34
    buffer_load_dword v35, v128, s[44:47], s35 offen
    s_cmp_lt_u32 s67, 32
    s_mov_b32 s35, 41472
    s_cselect_b32 s35, 9216, s35
    s_add_u32 s35, s35, s34
    buffer_load_dword v36, v128, s[44:47], s35 offen
    s_cmp_lt_u32 s67, 32
    s_mov_b32 s35, 42624
    s_cselect_b32 s35, 10368, s35
    s_add_u32 s35, s35, s34
    buffer_load_dword v37, v128, s[44:47], s35 offen
    s_cmp_lt_u32 s67, 32
    s_mov_b32 s35, 62208
    s_cselect_b32 s35, 11520, s35
    s_add_u32 s35, s35, s34
    buffer_load_dword v38, v128, s[44:47], s35 offen
    s_cmp_lt_u32 s67, 32
    s_mov_b32 s35, 63360
    s_cselect_b32 s35, 12672, s35
    s_add_u32 s35, s35, s34
    buffer_load_dword v39, v128, s[44:47], s35 offen
    s_cmp_eq_u32 s28, 12
    s_cbranch_scc1 K1_GATE1
    s_waitcnt vmcnt(15)
    s_barrier
    s_branch K1_GATE1
K1_GATE0:
    s_mov_b32 s24, s14
    s_mov_b32 s25, s15
    s_mov_b32 s26, 1152
    s_mov_b32 s27, 0x00020000
    v_and_b32 v1, 31, v0
    v_lshrrev_b32 v2, 5, v0
    s_lshl_b32 s30, s2, 3
    s_lshl_b32 s31, s3, 1
    s_add_u32 s30, s30, s31
    v_add_u32 v3, s30, v2
    v_mul_u32_u24 v4, 1152, v3
    v_lshlrev_b32 v5, 4, v1
    v_add_u32 v4, v4, v5
    v_mov_b32 v6, 0x7ffffff0
    v_cmp_gt_u32 vcc, 8, v1
    buffer_load_dwordx4 v[40:43], v4, s[20:23], 0 offen
    buffer_load_dwordx4 v[44:47], v4, s[20:23], 0 offen offset:512
    v_cndmask_b32 v6, v6, v4, vcc
    buffer_load_dwordx4 v[52:55], v5, s[24:27], 0 offen
    buffer_load_dwordx4 v[48:51], v6, s[20:23], 0 offen offset:1024
    buffer_load_dwordx4 v[56:59], v5, s[24:27], 0 offen offset:512
    buffer_load_dwordx4 v[60:63], v5, s[24:27], 0 offen offset:1024
    s_mov_b32 s62, 256
    s_mov_b32 s63, 0x00020000
    v_mov_b32 v64, 128
    buffer_load_dword v65, v64, s[60:63], 0 offen sc1
    s_lshl_b32 s66, s2, 2
    s_add_u32 s66, s66, s3
    s_min_u32 s66, s66, 647
    s_mul_i32 s67, s66, 3641
    s_lshr_b32 s67, s67, 16
    s_mul_i32 s68, s67, 18
    s_sub_u32 s68, s66, s68
    s_and_b32 s34, s67, 15
    s_mul_i32 s34, s34, 41472
    s_and_b32 s35, s67, 1
    s_mul_i32 s35, s35, 331776
    s_add_u32 s35, s35, 18432
    s_lshr_b32 s37, s67, 4
    s_bfe_u32 s36, s67, 0x10001
    s_cmp_lt_u32 s67, 32
    s_cselect_b32 s34, s34, s35
    s_cselect_b32 s35, s37, s36
    s_cselect_b64 vcc, -1, 0
    s_cmp_eq_u32 s35, 0
    s_cselect_b32 s44, s56, s58
    s_cselect_b32 s45, s57, s59
    s_mov_b32 s46, 663552
    s_mov_b32 s47, 0x00020000
    s_lshl_b32 s66, s68, 6
    s_add_u32 s34, s34, s66
    v_lshrrev_b32 v127, 4, v0
    v_lshrrev_b32 v128, 1, v127
    v_mul_u32_u24 v128, 18, v128
    v_and_b32 v129, 1, v127
    v_lshl_add_u32 v128, v129, 2, v128
    v_mul_u32_u24 v129, 72, v127
    v_cndmask_b32 v128, v129, v128, vcc
    v_mul_u32_u24 v128, 1152, v128
    v_and_b32 v127, 15, v0
    v_lshl_add_u32 v128, v127, 2, v128
    s_cmp_lt_u32 s67, 32
    s_mov_b32 s35, 0
    s_cselect_b32 s35, 0, s35
    s_add_u32 s35, s35, s34
    buffer_load_dword v32, v128, s[44:47], s35 offen
    s_cmp_lt_u32 s67, 32
    s_mov_b32 s35, 1152
    s_cselect_b32 s35, 1152, s35
    s_add_u32 s35, s35, s34
    buffer_load_dword v33, v128, s[44:47], s35 offen
    s_cmp_lt_u32 s67, 32
    s_mov_b32 s35, 20736
    s_cselect_b32 s35, 2304, s35
    s_add_u32 s35, s35, s34
    buffer_load_dword v34, v128, s[44:47], s35 offen
    s_cmp_lt_u32 s67, 32
    s_mov_b32 s35, 21888
    s_cselect_b32 s35, 3456, s35
    s_add_u32 s35, s35, s34
    buffer_load_dword v35, v128, s[44:47], s35 offen
    s_cmp_lt_u32 s67, 32
    s_mov_b32 s35, 41472
    s_cselect_b32 s35, 9216, s35
    s_add_u32 s35, s35, s34
    buffer_load_dword v36, v128, s[44:47], s35 offen
    s_cmp_lt_u32 s67, 32
    s_mov_b32 s35, 42624
    s_cselect_b32 s35, 10368, s35
    s_add_u32 s35, s35, s34
    buffer_load_dword v37, v128, s[44:47], s35 offen
    s_cmp_lt_u32 s67, 32
    s_mov_b32 s35, 62208
    s_cselect_b32 s35, 11520, s35
    s_add_u32 s35, s35, s34
    buffer_load_dword v38, v128, s[44:47], s35 offen
    s_cmp_lt_u32 s67, 32
    s_mov_b32 s35, 63360
    s_cselect_b32 s35, 12672, s35
    s_add_u32 s35, s35, s34
    buffer_load_dword v39, v128, s[44:47], s35 offen
K1_GATE1:
    s_waitcnt vmcnt(8)
    v_lshlrev_b32 v20, 16, v40
    v_lshlrev_b32 v21, 16, v52
    v_and_b32 v22, 0xffff0000, v40
    v_and_b32 v23, 0xffff0000, v52
    v_mul_f32 v4, v20, v21
    v_mul_f32 v5, v22, v23
    v_lshlrev_b32 v20, 16, v41
    v_lshlrev_b32 v21, 16, v53
    v_and_b32 v22, 0xffff0000, v41
    v_and_b32 v23, 0xffff0000, v53
    v_fmac_f32 v4, v20, v21
    v_fmac_f32 v5, v22, v23
    v_lshlrev_b32 v20, 16, v42
    v_lshlrev_b32 v21, 16, v54
    v_and_b32 v22, 0xffff0000, v42
    v_and_b32 v23, 0xffff0000, v54
    v_fmac_f32 v4, v20, v21
    v_fmac_f32 v5, v22, v23
    v_lshlrev_b32 v20, 16, v43
    v_lshlrev_b32 v21, 16, v55
    v_and_b32 v22, 0xffff0000, v43
    v_and_b32 v23, 0xffff0000, v55
    v_fmac_f32 v4, v20, v21
    v_fmac_f32 v5, v22, v23
    v_lshlrev_b32 v20, 16, v44
    v_lshlrev_b32 v21, 16, v56
    v_and_b32 v22, 0xffff0000, v44
    v_and_b32 v23, 0xffff0000, v56
    v_fmac_f32 v4, v20, v21
    v_fmac_f32 v5, v22, v23
    v_lshlrev_b32 v20, 16, v45
    v_lshlrev_b32 v21, 16, v57
    v_and_b32 v22, 0xffff0000, v45
    v_and_b32 v23, 0xffff0000, v57
    v_fmac_f32 v4, v20, v21
    v_fmac_f32 v5, v22, v23
    v_lshlrev_b32 v20, 16, v46
    v_lshlrev_b32 v21, 16, v58
    v_and_b32 v22, 0xffff0000, v46
    v_and_b32 v23, 0xffff0000, v58
    v_fmac_f32 v4, v20, v21
    v_fmac_f32 v5, v22, v23
    v_lshlrev_b32 v20, 16, v47
    v_lshlrev_b32 v21, 16, v59
    v_and_b32 v22, 0xffff0000, v47
    v_and_b32 v23, 0xffff0000, v59
    v_fmac_f32 v4, v20, v21
    v_fmac_f32 v5, v22, v23
    v_lshlrev_b32 v20, 16, v48
    v_lshlrev_b32 v21, 16, v60
    v_and_b32 v22, 0xffff0000, v48
    v_and_b32 v23, 0xffff0000, v60
    v_fmac_f32 v4, v20, v21
    v_fmac_f32 v5, v22, v23
    v_lshlrev_b32 v20, 16, v49
    v_lshlrev_b32 v21, 16, v61
    v_and_b32 v22, 0xffff0000, v49
    v_and_b32 v23, 0xffff0000, v61
    v_fmac_f32 v4, v20, v21
    v_fmac_f32 v5, v22, v23
    v_lshlrev_b32 v20, 16, v50
    v_lshlrev_b32 v21, 16, v62
    v_and_b32 v22, 0xffff0000, v50
    v_and_b32 v23, 0xffff0000, v62
    v_fmac_f32 v4, v20, v21
    v_fmac_f32 v5, v22, v23
    v_lshlrev_b32 v20, 16, v51
    v_lshlrev_b32 v21, 16, v63
    v_and_b32 v22, 0xffff0000, v51
    v_and_b32 v23, 0xffff0000, v63
    v_fmac_f32 v4, v20, v21
    v_fmac_f32 v5, v22, v23
    v_add_f32 v4, v4, v5
    s_nop 1
    v_add_f32_dpp v4, v4, v4 quad_perm:[1,0,3,2] row_mask:0xf bank_mask:0xf
    s_nop 1
    v_add_f32_dpp v4, v4, v4 quad_perm:[2,3,0,1] row_mask:0xf bank_mask:0xf
    s_nop 1
    v_add_f32_dpp v4, v4, v4 row_half_mirror row_mask:0xf bank_mask:0xf
    s_nop 1
    v_add_f32_dpp v4, v4, v4 row_mirror row_mask:0xf bank_mask:0xf
    v_mov_b32 v5, v4
    s_nop 1
    v_permlane16_swap_b32 v4, v5
    s_nop 1
    v_add_f32 v4, v4, v5
    v_mul_f32 v4, 0xbfb8aa3b, v4
    v_exp_f32 v4, v4
    s_nop 0
    v_add_f32 v4, 1.0, v4
    v_rcp_f32 v66, v4
    s_branch K2_STG0
K1_COMPUTE:
    s_sub_u32 s3, s3, 4
    s_lshl_b32 s30, s29, 2
    s_add_u32 s30, s30, s3
    s_mul_i32 s31, s30, 3641
    s_lshr_b32 s31, s31, 16
    s_mul_i32 s32, s31, 18
    s_sub_u32 s32, s30, s32
    v_and_b32 v1, 31, v0
    v_lshrrev_b32 v2, 5, v0
    v_bfe_u32 v3, v0, 2, 2
    v_and_b32 v4, 3, v0
    v_bfe_u32 v5, v0, 4, 1
    v_lshl_add_u32 v4, v5, 2, v4
    v_lshl_add_u32 v6, v2, 3, v3
    v_lshlrev_b32 v6, 8, v6
    v_xor_b32 v7, s3, v3
    v_lshl_add_u32 v6, v7, 6, v6
    s_load_dwordx2 s[24:25], s[0:1], 80
    s_mov_b32 s26, 256
    s_mov_b32 s27, 0x00020000
    s_waitcnt lgkmcnt(0)
    s_mov_b32 s40, s16
    s_mov_b32 s41, s17
    s_mov_b32 s42, 18087936
    s_mov_b32 s43, 0x00020000
    s_mov_b32 s20, s4
    s_mov_b32 s21, s5
    s_mov_b32 s22, 2359296
    s_mov_b32 s23, 0x00020000
    s_load_dwordx2 s[6:7], s[0:1], 72
    s_and_b32 s10, s2, 7
    s_lshl_b32 s10, s10, 2
    s_bfe_u32 s11, s2, 0x20005
    s_add_u32 s10, s10, s11
    s_lshr_b32 s11, s2, 7
    s_lshl_b32 s11, s11, 5
    s_add_u32 s10, s10, s11
    s_bfe_u32 s11, s2, 0x20003
    s_lshl_b32 s13, s69, 10
    s_lshl_b32 s14, s11, 3
    s_and_b32 s15, s69, 3
    s_lshl_b32 s15, s15, 1
    s_add_u32 s14, s14, s15
    s_cmp_lt_u32 s69, 4
    s_cselect_b32 s15, 32, 0
    s_add_u32 s14, s14, s15
    s_lshl_b32 s66, s10, 16
    s_lshl_b32 s15, s14, 10
    s_add_u32 s66, s66, s15
    s_add_u32 s66, s66, 5242880
    s_lshl_b32 s67, s10, 13
    s_lshl_b32 s15, s14, 7
    s_add_u32 s67, s67, s15
    s_add_u32 s67, s67, 9437184
    s_waitcnt lgkmcnt(0)
    s_or_b32 s36, s2, s3
    s_cbranch_scc1 K1_NOTAG
    s_memrealtime s[36:37]
    s_waitcnt lgkmcnt(0)
    s_or_b32 s36, s36, 1
    v_mov_b32 v30, 0
    v_mov_b32 v31, s36
    buffer_store_dword v31, v30, s[24:27], 0 offen offset:128 sc1
    s_nop 1
K1_NOTAG:
    s_mov_b32 s70, 0x7ffffff0
    s_cmp_ge_u32 s18, 247
    s_cbranch_scc1 K1_CEND
    s_mul_i32 s70, s30, 13
    s_add_u32 s70, s70, s28
    s_lshl_b32 s70, s70, 8
    s_add_u32 s70, s70, 17301504
    s_lshl_b32 s36, s18, 2
    s_add_u32 s36, s36, s3
    s_lshl_b32 s37, s36, 2
    s_lshl_b32 s36, s36, 3
    s_add_u32 s36, s36, 11232
    v_add_u32 v30, s36, v0
    v_and_b32 v31, 3, v0
    v_add_u32 v31, s37, v31
    v_mul_u32_u24 v28, 3641, v31
    v_lshrrev_b32 v28, 20, v28
    v_cmp_gt_u32 vcc, 8, v0
    v_add_u32 v28, 1, v28
    v_mul_u32_u24 v28, 576, v28
    v_add_u32 v31, v31, v28
    v_cndmask_b32 v30, v31, v30, vcc
    v_lshlrev_b32 v30, 7, v30
    v_mov_b32 v22, 0x7ffffff0
    v_cmp_gt_u32 vcc, 32, v0
    v_mov_b32 v28, 128
    v_lshlrev_b32 v23, 2, v0
    v_cndmask_b32 v22, v22, v23, vcc
    s_cmp_eq_u32 s31, 2
    s_cbranch_scc1 K1_VTYPE
    s_cmp_eq_u32 s30, 73
    s_cbranch_scc1 K1_VTYPE
    v_mov_b32 v40, v1
    s_add_u32 s33, s32, 4
    s_cmp_ge_u32 s33, 9
    s_cselect_b32 s35, 9, 0
    s_sub_u32 s33, s33, s35
    s_cmp_ge_u32 s33, 9
    s_cselect_b32 s35, 9, 0
    s_sub_u32 s33, s33, s35
    s_cmp_ge_u32 s30, 72
    s_cselect_b32 s33, 8, s33
    s_min_u32 s35, s33, 7
    v_add_u32 v41, 1, v4
    v_cmp_le_u32 vcc, s33, v4
    v_mov_b32 v42, s35
    s_nop 0
    v_cndmask_b32 v41, v4, v41, vcc
    v_cmp_eq_u32 vcc, 7, v4
    s_nop 1
    v_cndmask_b32 v41, v41, v42, vcc
    v_lshl_add_u32 v6, v41, 3, v6
    v_bfe_u32 v41, v40, 1, 3
    v_xor_b32 v41, v41, v2
    v_lshlrev_b32 v41, 4, v41
    v_lshl_add_u32 v8, v40, 7, v41
    v_xor_b32 v9, 32, v8
    v_xor_b32 v10, 64, v8
    v_xor_b32 v11, 96, v8
    s_mov_b32 s48, 73728
    s_mov_b32 s49, 73728
    s_mov_b32 s50, 1.0
    s_mov_b32 s44, 0
    s_mov_b32 s45, 8192
    s_mov_b32 s46, 9216
    s_mov_b32 s47, 9216
    s_cmp_eq_u32 s31, 1
    s_cbranch_scc1 K1_SQ1
    s_cmp_eq_u32 s31, 4
    s_cbranch_scc1 K1_SQ1
    s_mov_b32 s48, 65536
    s_mov_b32 s49, 8192
    s_mov_b32 s50, 0x3eae1a93
    s_cmp_eq_u32 s31, 3
    s_cselect_b32 s35, 2048, 0
    s_lshl_b32 s44, s35, 10
    s_add_u32 s44, s44, 5242880
    s_lshl_b32 s45, s35, 7
    s_add_u32 s45, s45, 9437184
    s_mov_b32 s46, 8192
    s_mov_b32 s47, 1024
K1_SQ1:
    s_mul_i32 s34, s28, 3
    s_add_u32 s34, s34, 0
    s_lshr_b32 s35, s34, 3
    s_and_b32 s34, s34, 7
    s_mul_i32 s56, s35, s46
    s_mul_i32 s57, s35, s47
    s_lshl_b32 s35, s34, 10
    s_add_u32 s56, s56, s35
    s_add_u32 s56, s56, s44
    s_lshl_b32 s35, s34, 7
    s_add_u32 s57, s57, s35
    s_add_u32 s57, s57, s45
    s_mul_i32 s34, s28, 3
    s_add_u32 s34, s34, 1
    s_lshr_b32 s35, s34, 3
    s_and_b32 s34, s34, 7
    s_mul_i32 s58, s35, s46
    s_mul_i32 s59, s35, s47
    s_lshl_b32 s35, s34, 10
    s_add_u32 s58, s58, s35
    s_add_u32 s58, s58, s44
    s_lshl_b32 s35, s34, 7
    s_add_u32 s59, s59, s35
    s_add_u32 s59, s59, s45
    s_mul_i32 s34, s28, 3
    s_add_u32 s34, s34, 2
    s_lshr_b32 s35, s34, 3
    s_and_b32 s34, s34, 7
    s_mul_i32 s60, s35, s46
    s_mul_i32 s61, s35, s47
    s_lshl_b32 s35, s34, 10
    s_add_u32 s60, s60, s35
    s_add_u32 s60, s60, s44
    s_lshl_b32 s35, s34, 7
    s_add_u32 s61, s61, s35
    s_add_u32 s61, s61, s45
    s_mul_i32 s34, s28, 2
    s_add_u32 s34, s34, 39
    s_lshr_b32 s35, s34, 3
    s_and_b32 s34, s34, 7
    s_mul_i32 s62, s35, s46
    s_mul_i32 s63, s35, s47
    s_lshl_b32 s35, s34, 10
    s_add_u32 s62, s62, s35
    s_add_u32 s62, s62, s44
    s_lshl_b32 s35, s34, 7
    s_add_u32 s63, s63, s35
    s_add_u32 s63, s63, s45
    s_mul_i32 s34, s28, 2
    s_add_u32 s34, s34, 40
    s_lshr_b32 s35, s34, 3
    s_and_b32 s34, s34, 7
    s_mul_i32 s64, s35, s46
    s_mul_i32 s65, s35, s47
    s_lshl_b32 s35, s34, 10
    s_add_u32 s64, s64, s35
    s_add_u32 s64, s64, s44
    s_lshl_b32 s35, s34, 7
    s_add_u32 s65, s65, s35
    s_add_u32 s65, s65, s45
    s_lshl_b32 s36, s32, 3
    s_min_u32 s35, s33, 7
    v_mov_b32 v46, 0x7ffffff0
    v_add_u32 v3, 0, v2
    v_add_u32 v5, 1, v3
    v_cmp_le_u32 vcc, s33, v3
    s_nop 1
    v_cndmask_b32 v3, v3, v5, vcc
    v_add_u32 v3, s36, v3
    v_mul_u32_u24 v5, 7282, v3
    v_lshrrev_b32 v5, 16, v5
    v_mul_u32_u24 v45, 9, v5
    v_sub_u32 v3, v3, v45
    v_cmp_lt_u32 vcc, 4, v3
    v_lshlrev_b32 v5, 1, v5
    v_subrev_u32 v45, 5, v3
    v_addc_co_u32 v43, s[52:53], 0, v5, vcc
    v_cndmask_b32 v45, v3, v45, vcc
    v_mul_lo_u32 v43, v43, s48
    v_lshl_add_u32 v43, v45, 8, v43
    v_lshl_add_u32 v16, v1, 3, v43
    v_add_u32 v3, 2, v2
    v_add_u32 v5, 1, v3
    v_cmp_le_u32 vcc, s33, v3
    s_nop 1
    v_cndmask_b32 v3, v3, v5, vcc
    v_add_u32 v3, s36, v3
    v_mul_u32_u24 v5, 7282, v3
    v_lshrrev_b32 v5, 16, v5
    v_mul_u32_u24 v45, 9, v5
    v_sub_u32 v3, v3, v45
    v_cmp_lt_u32 vcc, 4, v3
    v_lshlrev_b32 v5, 1, v5
    v_subrev_u32 v45, 5, v3
    v_addc_co_u32 v43, s[52:53], 0, v5, vcc
    v_cndmask_b32 v45, v3, v45, vcc
    v_mul_lo_u32 v43, v43, s48
    v_lshl_add_u32 v43, v45, 8, v43
    v_lshl_add_u32 v17, v1, 3, v43
    v_add_u32 v3, 4, v2
    v_add_u32 v5, 1, v3
    v_cmp_le_u32 vcc, s33, v3
    s_nop 1
    v_cndmask_b32 v3, v3, v5, vcc
    v_add_u32 v3, s36, v3
    v_mul_u32_u24 v5, 7282, v3
    v_lshrrev_b32 v5, 16, v5
    v_mul_u32_u24 v45, 9, v5
    v_sub_u32 v3, v3, v45
    v_cmp_lt_u32 vcc, 4, v3
    v_lshlrev_b32 v5, 1, v5
    v_subrev_u32 v45, 5, v3
    v_addc_co_u32 v43, s[52:53], 0, v5, vcc
    v_cndmask_b32 v45, v3, v45, vcc
    v_mul_lo_u32 v43, v43, s48
    v_lshl_add_u32 v43, v45, 8, v43
    v_lshl_add_u32 v18, v1, 3, v43
    v_add_u32 v3, 6, v2
    v_add_u32 v5, 1, v3
    v_cmp_le_u32 vcc, s33, v3
    s_nop 1
    v_cndmask_b32 v3, v3, v5, vcc
    v_mov_b32 v5, s35
    v_cmp_eq_u32 vcc, 1, v2
    s_nop 1
    v_cndmask_b32 v3, v3, v5, vcc
    v_add_u32 v3, s36, v3
    v_mul_u32_u24 v5, 7282, v3
    v_lshrrev_b32 v5, 16, v5
    v_mul_u32_u24 v45, 9, v5
    v_sub_u32 v3, v3, v45
    v_cmp_lt_u32 vcc, 4, v3
    v_lshlrev_b32 v5, 1, v5
    v_subrev_u32 v45, 5, v3
    v_addc_co_u32 v43, s[52:53], 0, v5, vcc
    v_cndmask_b32 v45, v3, v45, vcc
    v_mul_lo_u32 v43, v43, s48
    v_lshl_add_u32 v43, v45, 8, v43
    v_lshl_add_u32 v19, v1, 3, v43
    v_cmp_eq_u32 vcc, 4, v3
    v_mul_lo_u32 v5, v5, s49
    v_lshl_add_u32 v5, v1, 2, v5
    v_cndmask_b32 v19, v19, v46, vcc
    v_cndmask_b32 v20, v46, v5, vcc
    v_add_u32 v21, s49, v20
    s_cmp_lt_u32 s30, 72
    s_cbranch_scc1 K1_SQ2
    v_lshlrev_b32 v3, 3, v1
    v_lshl_add_u32 v3, v2, 8, v3
    v_add_u32 v16, 2359296, v3
    v_add_u32 v17, 2359808, v3
    v_add_u32 v18, 2433024, v3
    v_add_u32 v19, 2433536, v3
    v_lshlrev_b32 v3, 2, v1
    v_add_u32 v5, 2433024, v3
    v_add_u32 v3, 2359296, v3
    v_cmp_eq_u32 vcc, 1, v2
    s_nop 1
    v_cndmask_b32 v20, v5, v46, vcc
    v_cndmask_b32 v21, v46, v3, vcc
    s_cmp_eq_u32 s30, 72
    s_cbranch_scc1 K1_SQ2
    v_mov_b32 v16, v46
    v_mov_b32 v17, v46
    v_mov_b32 v18, v46
    v_mov_b32 v19, v46
    v_mov_b32 v20, v46
    v_mov_b32 v21, v46
K1_SQ2:
    v_cmp_eq_u32 s[54:55], 1, v2
    s_setprio 1
    v_add_u32 v12, 0, v8
    v_add_u32 v13, 0, v9
    v_add_u32 v14, 0, v10
    v_add_u32 v15, 0, v11
    v_add_u32 v7, 0, v6
    s_barrier
    buffer_load_dword v31, v30, s[20:23], 0 offen
    ds_read_b64_tr_b16 v[112:113], v7 offset:0
    ds_read_b64_tr_b16 v[114:115], v7 offset:1024
    ds_read_b128 v[32:35], v12 offset:16384
    ds_read_b128 v[36:39], v12 offset:20480
    ds_read_b64_tr_b16 v[116:117], v7 offset:4096
    ds_read_b64_tr_b16 v[118:119], v7 offset:5120
    ds_read_b128 v[40:43], v13 offset:16384
    ds_read_b128 v[44:47], v13 offset:20480
    ds_read_b64_tr_b16 v[120:121], v7 offset:8192
    ds_read_b64_tr_b16 v[122:123], v7 offset:9216
    ds_read_b128 v[48:51], v14 offset:16384
    ds_read_b128 v[52:55], v14 offset:20480
    s_waitcnt lgkmcnt(8)
    ds_read_b64_tr_b16 v[124:125], v7 offset:12288
    ds_read_b64_tr_b16 v[126:127], v7 offset:13312
    v_mfma_f32_32x32x16_bf16 v[64:79], v[112:115], v[32:35], 0
    ds_read_b128 v[56:59], v15 offset:16384
    ds_read_b128 v[60:63], v15 offset:20480
    v_mfma_f32_32x32x16_bf16 v[80:95], v[112:115], v[36:39], 0
    s_waitcnt lgkmcnt(8)
    v_add_u32 v12, 24576, v8
    v_add_u32 v13, 24576, v9
    v_add_u32 v14, 24576, v10
    v_add_u32 v15, 24576, v11
    v_add_u32 v7, 24576, v6
    s_barrier
    ds_read_b64_tr_b16 v[128:129], v7 offset:0
    ds_read_b64_tr_b16 v[130:131], v7 offset:1024
    v_mfma_f32_32x32x16_bf16 v[64:79], v[116:119], v[40:43], v[64:79]
    ds_read_b128 v[32:35], v12 offset:16384
    ds_read_b128 v[36:39], v12 offset:20480
    v_mfma_f32_32x32x16_bf16 v[80:95], v[116:119], v[44:47], v[80:95]
    s_waitcnt lgkmcnt(8)
    ds_read_b64_tr_b16 v[132:133], v7 offset:4096
    ds_read_b64_tr_b16 v[134:135], v7 offset:5120
    v_mfma_f32_32x32x16_bf16 v[64:79], v[120:123], v[48:51], v[64:79]
    ds_read_b128 v[40:43], v13 offset:16384
    ds_read_b128 v[44:47], v13 offset:20480
    v_mfma_f32_32x32x16_bf16 v[80:95], v[120:123], v[52:55], v[80:95]
    s_waitcnt lgkmcnt(8)
    ds_read_b64_tr_b16 v[136:137], v7 offset:8192
    ds_read_b64_tr_b16 v[138:139], v7 offset:9216
    v_mfma_f32_32x32x16_bf16 v[64:79], v[124:127], v[56:59], v[64:79]
    ds_read_b128 v[48:51], v14 offset:16384
    ds_read_b128 v[52:55], v14 offset:20480
    v_mfma_f32_32x32x16_bf16 v[80:95], v[124:127], v[60:63], v[80:95]
    s_waitcnt lgkmcnt(8)
    ds_read_b64_tr_b16 v[140:141], v7 offset:12288
    ds_read_b64_tr_b16 v[142:143], v7 offset:13312
    v_mfma_f32_32x32x16_bf16 v[64:79], v[128:131], v[32:35], v[64:79]
    ds_read_b128 v[56:59], v15 offset:16384
    ds_read_b128 v[60:63], v15 offset:20480
    v_mfma_f32_32x32x16_bf16 v[80:95], v[128:131], v[36:39], v[80:95]
    s_waitcnt lgkmcnt(8)
    v_add_u32 v12, 49152, v8
    v_add_u32 v13, 49152, v9
    v_add_u32 v14, 49152, v10
    v_add_u32 v15, 49152, v11
    v_add_u32 v7, 49152, v6
    s_barrier
    ds_read_b64_tr_b16 v[144:145], v7 offset:0
    ds_read_b64_tr_b16 v[146:147], v7 offset:1024
    v_mfma_f32_32x32x16_bf16 v[64:79], v[132:135], v[40:43], v[64:79]
    ds_read_b128 v[32:35], v12 offset:16384
    ds_read_b128 v[36:39], v12 offset:20480
    v_mfma_f32_32x32x16_bf16 v[80:95], v[132:135], v[44:47], v[80:95]
    s_waitcnt lgkmcnt(8)
    ds_read_b64_tr_b16 v[148:149], v7 offset:4096
    ds_read_b64_tr_b16 v[150:151], v7 offset:5120
    v_mfma_f32_32x32x16_bf16 v[64:79], v[136:139], v[48:51], v[64:79]
    ds_read_b128 v[40:43], v13 offset:16384
    ds_read_b128 v[44:47], v13 offset:20480
    v_mfma_f32_32x32x16_bf16 v[80:95], v[136:139], v[52:55], v[80:95]
    s_waitcnt lgkmcnt(8)
    ds_read_b64_tr_b16 v[152:153], v7 offset:8192
    ds_read_b64_tr_b16 v[154:155], v7 offset:9216
    v_mfma_f32_32x32x16_bf16 v[64:79], v[140:143], v[56:59], v[64:79]
    ds_read_b128 v[48:51], v14 offset:16384
    ds_read_b128 v[52:55], v14 offset:20480
    v_mfma_f32_32x32x16_bf16 v[80:95], v[140:143], v[60:63], v[80:95]
    s_waitcnt lgkmcnt(8)
    ds_read_b64_tr_b16 v[156:157], v7 offset:12288
    ds_read_b64_tr_b16 v[158:159], v7 offset:13312
    v_mfma_f32_32x32x16_bf16 v[64:79], v[144:147], v[32:35], v[64:79]
    ds_read_b128 v[56:59], v15 offset:16384
    ds_read_b128 v[60:63], v15 offset:20480
    v_mfma_f32_32x32x16_bf16 v[80:95], v[144:147], v[36:39], v[80:95]
    s_waitcnt lgkmcnt(8)
    v_add_u32 v12, 73728, v8
    v_add_u32 v13, 73728, v9
    v_add_u32 v14, 73728, v10
    v_add_u32 v15, 73728, v11
    v_add_u32 v7, 73728, v6
    s_barrier
    ds_read_b64_tr_b16 v[160:161], v7 offset:0
    ds_read_b64_tr_b16 v[162:163], v7 offset:1024
    v_mfma_f32_32x32x16_bf16 v[64:79], v[148:151], v[40:43], v[64:79]
    ds_read_b128 v[32:35], v12 offset:16384
    ds_read_b128 v[36:39], v12 offset:20480
    v_mfma_f32_32x32x16_bf16 v[80:95], v[148:151], v[44:47], v[80:95]
    s_waitcnt lgkmcnt(8)
    ds_read_b64_tr_b16 v[164:165], v7 offset:4096
    ds_read_b64_tr_b16 v[166:167], v7 offset:5120
    v_mfma_f32_32x32x16_bf16 v[64:79], v[152:155], v[48:51], v[64:79]
    ds_read_b128 v[40:43], v13 offset:16384
    ds_read_b128 v[44:47], v13 offset:20480
    v_mfma_f32_32x32x16_bf16 v[80:95], v[152:155], v[52:55], v[80:95]
    s_waitcnt lgkmcnt(8)
    ds_read_b64_tr_b16 v[168:169], v7 offset:8192
    ds_read_b64_tr_b16 v[170:171], v7 offset:9216
    v_mfma_f32_32x32x16_bf16 v[64:79], v[156:159], v[56:59], v[64:79]
    ds_read_b128 v[48:51], v14 offset:16384
    ds_read_b128 v[52:55], v14 offset:20480
    v_mfma_f32_32x32x16_bf16 v[80:95], v[156:159], v[60:63], v[80:95]
    s_waitcnt lgkmcnt(8)
    ds_read_b64_tr_b16 v[172:173], v7 offset:12288
    ds_read_b64_tr_b16 v[174:175], v7 offset:13312
    v_mfma_f32_32x32x16_bf16 v[64:79], v[160:163], v[32:35], v[64:79]
    ds_read_b128 v[56:59], v15 offset:16384
    ds_read_b128 v[60:63], v15 offset:20480
    v_mfma_f32_32x32x16_bf16 v[80:95], v[160:163], v[36:39], v[80:95]
    s_waitcnt lgkmcnt(8)
    v_add_u32 v12, 98304, v8
    v_add_u32 v13, 98304, v9
    v_add_u32 v14, 98304, v10
    v_add_u32 v15, 98304, v11
    v_add_u32 v7, 98304, v6
    s_barrier
    ds_read_b64_tr_b16 v[176:177], v7 offset:0
    ds_read_b64_tr_b16 v[178:179], v7 offset:1024
    v_mfma_f32_32x32x16_bf16 v[64:79], v[164:167], v[40:43], v[64:79]
    ds_read_b128 v[32:35], v12 offset:16384
    ds_read_b128 v[36:39], v12 offset:20480
    v_mfma_f32_32x32x16_bf16 v[80:95], v[164:167], v[44:47], v[80:95]
    s_waitcnt lgkmcnt(8)
    ds_read_b64_tr_b16 v[180:181], v7 offset:4096
    ds_read_b64_tr_b16 v[182:183], v7 offset:5120
    v_mfma_f32_32x32x16_bf16 v[64:79], v[168:171], v[48:51], v[64:79]
    ds_read_b128 v[40:43], v13 offset:16384
    ds_read_b128 v[44:47], v13 offset:20480
    v_mfma_f32_32x32x16_bf16 v[80:95], v[168:171], v[52:55], v[80:95]
    s_waitcnt lgkmcnt(8)
    ds_read_b64_tr_b16 v[184:185], v7 offset:8192
    ds_read_b64_tr_b16 v[186:187], v7 offset:9216
    v_mfma_f32_32x32x16_bf16 v[64:79], v[172:175], v[56:59], v[64:79]
    ds_read_b128 v[48:51], v14 offset:16384
    ds_read_b128 v[52:55], v14 offset:20480
    v_mfma_f32_32x32x16_bf16 v[80:95], v[172:175], v[60:63], v[80:95]
    s_waitcnt lgkmcnt(8)
    ds_read_b64_tr_b16 v[188:189], v7 offset:12288
    ds_read_b64_tr_b16 v[190:191], v7 offset:13312
    v_mfma_f32_32x32x16_bf16 v[64:79], v[176:179], v[32:35], v[64:79]
    ds_read_b128 v[56:59], v15 offset:16384
    ds_read_b128 v[60:63], v15 offset:20480
    v_mfma_f32_32x32x16_bf16 v[80:95], v[176:179], v[36:39], v[80:95]
    s_waitcnt lgkmcnt(8)
    v_add_u32 v12, 122880, v8
    v_add_u32 v13, 122880, v9
    v_add_u32 v14, 122880, v10
    v_add_u32 v15, 122880, v11
    v_add_u32 v7, 122880, v6
    s_barrier
    ds_read_b64_tr_b16 v[192:193], v7 offset:0
    ds_read_b64_tr_b16 v[194:195], v7 offset:1024
    v_mfma_f32_32x32x16_bf16 v[64:79], v[180:183], v[40:43], v[64:79]
    ds_read_b128 v[32:35], v12 offset:16384
    ds_read_b128 v[36:39], v12 offset:20480
    v_mfma_f32_32x32x16_bf16 v[80:95], v[180:183], v[44:47], v[80:95]
    s_waitcnt lgkmcnt(8)
    ds_read_b64_tr_b16 v[196:197], v7 offset:4096
    ds_read_b64_tr_b16 v[198:199], v7 offset:5120
    v_mfma_f32_32x32x16_bf16 v[64:79], v[184:187], v[48:51], v[64:79]
    ds_read_b128 v[40:43], v13 offset:16384
    ds_read_b128 v[44:47], v13 offset:20480
    v_mfma_f32_32x32x16_bf16 v[80:95], v[184:187], v[52:55], v[80:95]
    s_waitcnt lgkmcnt(8)
    ds_read_b64_tr_b16 v[200:201], v7 offset:8192
    ds_read_b64_tr_b16 v[202:203], v7 offset:9216
    v_mfma_f32_32x32x16_bf16 v[64:79], v[188:191], v[56:59], v[64:79]
    ds_read_b128 v[48:51], v14 offset:16384
    ds_read_b128 v[52:55], v14 offset:20480
    v_mfma_f32_32x32x16_bf16 v[80:95], v[188:191], v[60:63], v[80:95]
    s_waitcnt lgkmcnt(8)
    ds_read_b64_tr_b16 v[204:205], v7 offset:12288
    ds_read_b64_tr_b16 v[206:207], v7 offset:13312
    v_mfma_f32_32x32x16_bf16 v[64:79], v[192:195], v[32:35], v[64:79]
    ds_read_b128 v[56:59], v15 offset:16384
    ds_read_b128 v[60:63], v15 offset:20480
    v_mfma_f32_32x32x16_bf16 v[80:95], v[192:195], v[36:39], v[80:95]
    s_waitcnt lgkmcnt(8)
    v_add_u32 v12, 0, v8
    v_add_u32 v13, 0, v9
    v_add_u32 v14, 0, v10
    v_add_u32 v15, 0, v11
    v_add_u32 v7, 0, v6
    s_barrier
    ds_read_b64_tr_b16 v[208:209], v7 offset:0
    ds_read_b64_tr_b16 v[210:211], v7 offset:1024
    v_mfma_f32_32x32x16_bf16 v[64:79], v[196:199], v[40:43], v[64:79]
    ds_read_b128 v[32:35], v12 offset:16384
    ds_read_b128 v[36:39], v12 offset:20480
    v_mfma_f32_32x32x16_bf16 v[80:95], v[196:199], v[44:47], v[80:95]
    s_waitcnt lgkmcnt(8)
    ds_read_b64_tr_b16 v[212:213], v7 offset:4096
    ds_read_b64_tr_b16 v[214:215], v7 offset:5120
    v_mfma_f32_32x32x16_bf16 v[64:79], v[200:203], v[48:51], v[64:79]
    ds_read_b128 v[40:43], v13 offset:16384
    ds_read_b128 v[44:47], v13 offset:20480
    v_mfma_f32_32x32x16_bf16 v[80:95], v[200:203], v[52:55], v[80:95]
    s_waitcnt lgkmcnt(8)
    ds_read_b64_tr_b16 v[216:217], v7 offset:8192
    ds_read_b64_tr_b16 v[218:219], v7 offset:9216
    v_mfma_f32_32x32x16_bf16 v[64:79], v[204:207], v[56:59], v[64:79]
    ds_read_b128 v[48:51], v14 offset:16384
    ds_read_b128 v[52:55], v14 offset:20480
    v_mfma_f32_32x32x16_bf16 v[80:95], v[204:207], v[60:63], v[80:95]
    s_waitcnt lgkmcnt(8)
    ds_read_b64_tr_b16 v[220:221], v7 offset:12288
    ds_read_b64_tr_b16 v[222:223], v7 offset:13312
    v_mfma_f32_32x32x16_bf16 v[64:79], v[208:211], v[32:35], v[64:79]
    ds_read_b128 v[56:59], v15 offset:16384
    ds_read_b128 v[60:63], v15 offset:20480
    v_mfma_f32_32x32x16_bf16 v[80:95], v[208:211], v[36:39], v[80:95]
    buffer_load_dword v23, v28, s[24:27], 0 offen sc1
    s_waitcnt lgkmcnt(8)
    v_add_u32 v12, 24576, v8
    v_add_u32 v13, 24576, v9
    v_add_u32 v14, 24576, v10
    v_add_u32 v15, 24576, v11
    v_add_u32 v7, 24576, v6
    s_barrier
    ds_read_b64_tr_b16 v[224:225], v7 offset:0
    ds_read_b64_tr_b16 v[226:227], v7 offset:1024
    v_mfma_f32_32x32x16_bf16 v[64:79], v[212:215], v[40:43], v[64:79]
    ds_read_b128 v[32:35], v12 offset:16384
    ds_read_b128 v[36:39], v12 offset:20480
    v_mfma_f32_32x32x16_bf16 v[80:95], v[212:215], v[44:47], v[80:95]
    s_waitcnt lgkmcnt(8)
    ds_read_b64_tr_b16 v[228:229], v7 offset:4096
    ds_read_b64_tr_b16 v[230:231], v7 offset:5120
    v_mfma_f32_32x32x16_bf16 v[64:79], v[216:219], v[48:51], v[64:79]
    ds_read_b128 v[40:43], v13 offset:16384
    ds_read_b128 v[44:47], v13 offset:20480
    v_mfma_f32_32x32x16_bf16 v[80:95], v[216:219], v[52:55], v[80:95]
    s_waitcnt lgkmcnt(8)
    ds_read_b64_tr_b16 v[232:233], v7 offset:8192
    ds_read_b64_tr_b16 v[234:235], v7 offset:9216
    v_mfma_f32_32x32x16_bf16 v[64:79], v[220:223], v[56:59], v[64:79]
    ds_read_b128 v[48:51], v14 offset:16384
    ds_read_b128 v[52:55], v14 offset:20480
    v_mfma_f32_32x32x16_bf16 v[80:95], v[220:223], v[60:63], v[80:95]
    s_waitcnt lgkmcnt(8)
    ds_read_b64_tr_b16 v[236:237], v7 offset:12288
    ds_read_b64_tr_b16 v[238:239], v7 offset:13312
    v_mfma_f32_32x32x16_bf16 v[64:79], v[224:227], v[32:35], v[64:79]
    ds_read_b128 v[56:59], v15 offset:16384
    ds_read_b128 v[60:63], v15 offset:20480
    v_mfma_f32_32x32x16_bf16 v[80:95], v[224:227], v[36:39], v[80:95]
    s_waitcnt lgkmcnt(8)
    v_add_u32 v12, 49152, v8
    v_add_u32 v13, 49152, v9
    v_add_u32 v14, 49152, v10
    v_add_u32 v15, 49152, v11
    v_add_u32 v7, 49152, v6
    s_barrier
    ds_read_b64_tr_b16 v[240:241], v7 offset:0
    ds_read_b64_tr_b16 v[242:243], v7 offset:1024
    v_mfma_f32_32x32x16_bf16 v[64:79], v[228:231], v[40:43], v[64:79]
    ds_read_b128 v[32:35], v12 offset:16384
    ds_read_b128 v[36:39], v12 offset:20480
    v_mfma_f32_32x32x16_bf16 v[80:95], v[228:231], v[44:47], v[80:95]
    s_waitcnt lgkmcnt(8)
    ds_read_b64_tr_b16 v[244:245], v7 offset:4096
    ds_read_b64_tr_b16 v[246:247], v7 offset:5120
    v_mfma_f32_32x32x16_bf16 v[64:79], v[232:235], v[48:51], v[64:79]
    ds_read_b128 v[40:43], v13 offset:16384
    ds_read_b128 v[44:47], v13 offset:20480
    v_mfma_f32_32x32x16_bf16 v[80:95], v[232:235], v[52:55], v[80:95]
    s_waitcnt lgkmcnt(8)
    ds_read_b64_tr_b16 v[248:249], v7 offset:8192
    ds_read_b64_tr_b16 v[250:251], v7 offset:9216
    v_mfma_f32_32x32x16_bf16 v[64:79], v[236:239], v[56:59], v[64:79]
    ds_read_b128 v[48:51], v14 offset:16384
    ds_read_b128 v[52:55], v14 offset:20480
    v_mfma_f32_32x32x16_bf16 v[80:95], v[236:239], v[60:63], v[80:95]
    s_waitcnt lgkmcnt(8)
    ds_read_b64_tr_b16 v[252:253], v7 offset:12288
    ds_read_b64_tr_b16 v[254:255], v7 offset:13312
    v_mfma_f32_32x32x16_bf16 v[64:79], v[240:243], v[32:35], v[64:79]
    ds_read_b128 v[56:59], v15 offset:16384
    ds_read_b128 v[60:63], v15 offset:20480
    v_mfma_f32_32x32x16_bf16 v[80:95], v[240:243], v[36:39], v[80:95]
    s_waitcnt lgkmcnt(8)
    v_add_u32 v12, 73728, v8
    v_add_u32 v13, 73728, v9
    v_add_u32 v14, 73728, v10
    v_add_u32 v15, 73728, v11
    s_barrier
    ds_read_b128 v[32:35], v12 offset:0
    ds_read_b128 v[36:39], v13 offset:0
    v_mfma_f32_32x32x16_bf16 v[64:79], v[244:247], v[40:43], v[64:79]
    v_mfma_f32_32x32x16_bf16 v[80:95], v[244:247], v[44:47], v[80:95]
    s_waitcnt lgkmcnt(6)
    ds_read_b128 v[40:43], v14 offset:0
    ds_read_b128 v[44:47], v15 offset:0
    v_mfma_f32_32x32x16_bf16 v[64:79], v[248:251], v[48:51], v[64:79]
    v_mfma_f32_32x32x16_bf16 v[80:95], v[248:251], v[52:55], v[80:95]
    s_waitcnt lgkmcnt(4)
    ds_read_b128 v[48:51], v12 offset:4096
    ds_read_b128 v[52:55], v13 offset:4096
    v_mfma_f32_32x32x16_bf16 v[64:79], v[252:255], v[56:59], v[64:79]
    v_mfma_f32_32x32x16_bf16 v[80:95], v[252:255], v[60:63], v[80:95]
    s_mov_b32 s35, 0
K1_TAGQ:
    s_waitcnt vmcnt(0)
    v_readfirstlane_b32 s71, v23
    s_add_u32 s35, s35, 1
    s_cmp_ge_u32 s35, 0x40000
    s_cbranch_scc1 K1_TAGDQ
    s_cmp_lg_u32 s71, 0
    s_cbranch_scc1 K1_TAGDQ
    buffer_load_dword v23, v28, s[24:27], 0 offen sc1
    s_branch K1_TAGQ
K1_TAGDQ:
    s_waitcnt lgkmcnt(5)
    v_mfma_f32_32x32x16_bf16 v[96:111], v[112:115], v[32:35], 0
    ds_read_b128 v[56:59], v14 offset:4096
    s_waitcnt lgkmcnt(5)
    v_mfma_f32_32x32x16_bf16 v[96:111], v[116:119], v[36:39], v[96:111]
    ds_read_b128 v[60:63], v15 offset:4096
    s_waitcnt lgkmcnt(5)
    v_mfma_f32_32x32x16_bf16 v[96:111], v[120:123], v[40:43], v[96:111]
    ds_read_b128 v[32:35], v12 offset:8192
    s_waitcnt lgkmcnt(5)
    v_mfma_f32_32x32x16_bf16 v[96:111], v[124:127], v[44:47], v[96:111]
    ds_read_b128 v[36:39], v13 offset:8192
    s_waitcnt lgkmcnt(5)
    v_mfma_f32_32x32x16_bf16 v[96:111], v[128:131], v[48:51], v[96:111]
    ds_read_b128 v[40:43], v14 offset:8192
    v_mul_f32 v64, s50, v64
    v_mul_f32 v65, s50, v65
    v_mul_f32 v66, s50, v66
    v_mul_f32 v67, s50, v67
    s_waitcnt lgkmcnt(5)
    v_mfma_f32_32x32x16_bf16 v[96:111], v[132:135], v[52:55], v[96:111]
    ds_read_b128 v[44:47], v15 offset:8192
    v_cvt_pk_bf16_f32 v24, v64, v65
    v_cvt_pk_bf16_f32 v25, v66, v67
    s_barrier
    s_waitcnt lgkmcnt(5)
    v_mfma_f32_32x32x16_bf16 v[96:111], v[136:139], v[56:59], v[96:111]
    ds_read_b128 v[48:51], v12 offset:12288
    buffer_store_dwordx2 v[24:25], v16, s[40:43], s56 offen sc1
    v_mul_f32 v68, s50, v68
    v_mul_f32 v69, s50, v69
    s_waitcnt lgkmcnt(5)
    v_mfma_f32_32x32x16_bf16 v[96:111], v[140:143], v[60:63], v[96:111]
    ds_read_b128 v[52:55], v13 offset:12288
    v_mul_f32 v70, s50, v70
    v_mul_f32 v71, s50, v71
    v_cvt_pk_bf16_f32 v26, v68, v69
    s_waitcnt lgkmcnt(5)
    v_mfma_f32_32x32x16_bf16 v[96:111], v[144:147], v[32:35], v[96:111]
    ds_read_b128 v[56:59], v14 offset:12288
    v_cvt_pk_bf16_f32 v27, v70, v71
    buffer_store_dwordx2 v[26:27], v17, s[40:43], s56 offen sc1
    s_waitcnt lgkmcnt(5)
    v_mfma_f32_32x32x16_bf16 v[96:111], v[148:151], v[36:39], v[96:111]
    ds_read_b128 v[60:63], v15 offset:12288
    v_mul_f32 v72, s50, v72
    v_mul_f32 v73, s50, v73
    v_mul_f32 v74, s50, v74
    v_mul_f32 v75, s50, v75
    s_waitcnt lgkmcnt(5)
    v_mfma_f32_32x32x16_bf16 v[96:111], v[152:155], v[40:43], v[96:111]
    ds_read_b128 v[32:35], v12 offset:16384
    v_cvt_pk_bf16_f32 v28, v72, v73
    v_cvt_pk_bf16_f32 v29, v74, v75
    s_waitcnt lgkmcnt(5)
    v_mfma_f32_32x32x16_bf16 v[96:111], v[156:159], v[44:47], v[96:111]
    ds_read_b128 v[36:39], v13 offset:16384
    buffer_store_dwordx2 v[28:29], v18, s[40:43], s56 offen sc1
    v_mul_f32 v76, s50, v76
    v_mul_f32 v77, s50, v77
    s_waitcnt lgkmcnt(5)
    v_mfma_f32_32x32x16_bf16 v[96:111], v[160:163], v[48:51], v[96:111]
    ds_read_b128 v[40:43], v14 offset:16384
    v_mul_f32 v78, s50, v78
    v_mul_f32 v79, s50, v79
    v_cvt_pk_bf16_f32 v30, v76, v77
    s_waitcnt lgkmcnt(5)
    v_mfma_f32_32x32x16_bf16 v[96:111], v[164:167], v[52:55], v[96:111]
    ds_read_b128 v[44:47], v15 offset:16384
    v_cvt_pk_bf16_f32 v31, v78, v79
    buffer_store_dwordx2 v[30:31], v19, s[40:43], s56 offen sc1
    s_waitcnt lgkmcnt(5)
    v_mfma_f32_32x32x16_bf16 v[96:111], v[168:171], v[56:59], v[96:111]
    ds_read_b128 v[48:51], v12 offset:20480
    v_cndmask_b32 v64, v24, v30, s[54:55]
    buffer_store_dword v64, v20, s[40:43], s57 offen sc1
    s_waitcnt lgkmcnt(5)
    v_mfma_f32_32x32x16_bf16 v[96:111], v[172:175], v[60:63], v[96:111]
    ds_read_b128 v[52:55], v13 offset:20480
    buffer_store_dword v31, v21, s[40:43], s57 offen sc1
    v_mul_f32 v80, s50, v80
    v_mul_f32 v81, s50, v81
    s_waitcnt lgkmcnt(5)
    v_mfma_f32_32x32x16_bf16 v[96:111], v[176:179], v[32:35], v[96:111]
    ds_read_b128 v[56:59], v14 offset:20480
    v_mul_f32 v82, s50, v82
    v_mul_f32 v83, s50, v83
    v_cvt_pk_bf16_f32 v24, v80, v81
    s_waitcnt lgkmcnt(5)
    v_mfma_f32_32x32x16_bf16 v[96:111], v[180:183], v[36:39], v[96:111]
    ds_read_b128 v[60:63], v15 offset:20480
    v_cvt_pk_bf16_f32 v25, v82, v83
    buffer_store_dwordx2 v[24:25], v16, s[40:43], s58 offen sc1
    s_barrier
    s_waitcnt lgkmcnt(5)
    v_mfma_f32_32x32x16_bf16 v[96:111], v[184:187], v[40:43], v[96:111]
    ds_read_b128 v[32:35], v12 offset:24576
    v_mul_f32 v84, s50, v84
    v_mul_f32 v85, s50, v85
    v_mul_f32 v86, s50, v86
    v_mul_f32 v87, s50, v87
    s_waitcnt lgkmcnt(5)
    v_mfma_f32_32x32x16_bf16 v[96:111], v[188:191], v[44:47], v[96:111]
    ds_read_b128 v[36:39], v13 offset:24576
    v_cvt_pk_bf16_f32 v26, v84, v85
    v_cvt_pk_bf16_f32 v27, v86, v87
    s_waitcnt lgkmcnt(5)
    v_mfma_f32_32x32x16_bf16 v[96:111], v[192:195], v[48:51], v[96:111]
    ds_read_b128 v[40:43], v14 offset:24576
    buffer_store_dwordx2 v[26:27], v17, s[40:43], s58 offen sc1
    v_mul_f32 v88, s50, v88
    v_mul_f32 v89, s50, v89
    s_waitcnt lgkmcnt(5)
    v_mfma_f32_32x32x16_bf16 v[96:111], v[196:199], v[52:55], v[96:111]
    ds_read_b128 v[44:47], v15 offset:24576
    v_mul_f32 v90, s50, v90
    v_mul_f32 v91, s50, v91
    v_cvt_pk_bf16_f32 v28, v88, v89
    s_waitcnt lgkmcnt(5)
    v_mfma_f32_32x32x16_bf16 v[96:111], v[200:203], v[56:59], v[96:111]
    ds_read_b128 v[48:51], v12 offset:28672
    v_cvt_pk_bf16_f32 v29, v90, v91
    buffer_store_dwordx2 v[28:29], v18, s[40:43], s58 offen sc1
    s_waitcnt lgkmcnt(5)
    v_mfma_f32_32x32x16_bf16 v[96:111], v[204:207], v[60:63], v[96:111]
    ds_read_b128 v[52:55], v13 offset:28672
    v_mul_f32 v92, s50, v92
    v_mul_f32 v93, s50, v93
    v_mul_f32 v94, s50, v94
    v_mul_f32 v95, s50, v95
    s_waitcnt lgkmcnt(5)
    v_mfma_f32_32x32x16_bf16 v[96:111], v[208:211], v[32:35], v[96:111]
    ds_read_b128 v[56:59], v14 offset:28672
    v_cvt_pk_bf16_f32 v30, v92, v93
    v_cvt_pk_bf16_f32 v31, v94, v95
    s_waitcnt lgkmcnt(5)
    v_mfma_f32_32x32x16_bf16 v[96:111], v[212:215], v[36:39], v[96:111]
    ds_read_b128 v[60:63], v15 offset:28672
    buffer_store_dwordx2 v[30:31], v19, s[40:43], s58 offen sc1
    v_cndmask_b32 v80, v24, v30, s[54:55]
    s_waitcnt lgkmcnt(5)
    v_mfma_f32_32x32x16_bf16 v[96:111], v[216:219], v[40:43], v[96:111]
    ds_read_b128 v[32:35], v12 offset:32768
    buffer_store_dword v80, v20, s[40:43], s59 offen sc1
    buffer_store_dword v31, v21, s[40:43], s59 offen sc1
    s_waitcnt lgkmcnt(5)
    v_mfma_f32_32x32x16_bf16 v[96:111], v[220:223], v[44:47], v[96:111]
    ds_read_b128 v[36:39], v13 offset:32768
    s_waitcnt lgkmcnt(5)
    v_mfma_f32_32x32x16_bf16 v[96:111], v[224:227], v[48:51], v[96:111]
    ds_read_b128 v[40:43], v14 offset:32768
    s_waitcnt lgkmcnt(5)
    v_mfma_f32_32x32x16_bf16 v[96:111], v[228:231], v[52:55], v[96:111]
    ds_read_b128 v[44:47], v15 offset:32768
    v_add_u32 v12, 110592, v8
    v_add_u32 v13, 110592, v9
    v_add_u32 v14, 110592, v10
    v_add_u32 v15, 110592, v11
    s_barrier
    s_waitcnt lgkmcnt(5)
    v_mfma_f32_32x32x16_bf16 v[96:111], v[232:235], v[56:59], v[96:111]
    ds_read_b128 v[48:51], v12 offset:0
    s_waitcnt lgkmcnt(5)
    v_mfma_f32_32x32x16_bf16 v[96:111], v[236:239], v[60:63], v[96:111]
    ds_read_b128 v[52:55], v13 offset:0
    s_waitcnt lgkmcnt(5)
    v_mfma_f32_32x32x16_bf16 v[96:111], v[240:243], v[32:35], v[96:111]
    ds_read_b128 v[56:59], v14 offset:0
    s_waitcnt lgkmcnt(5)
    v_mfma_f32_32x32x16_bf16 v[96:111], v[244:247], v[36:39], v[96:111]
    ds_read_b128 v[60:63], v15 offset:0
    s_waitcnt lgkmcnt(5)
    v_mfma_f32_32x32x16_bf16 v[96:111], v[248:251], v[40:43], v[96:111]
    ds_read_b128 v[32:35], v12 offset:4096
    s_waitcnt lgkmcnt(5)
    v_mfma_f32_32x32x16_bf16 v[96:111], v[252:255], v[44:47], v[96:111]
    ds_read_b128 v[36:39], v13 offset:4096
    s_waitcnt lgkmcnt(5)
    v_mfma_f32_32x32x16_bf16 v[64:79], v[112:115], v[48:51], 0
    ds_read_b128 v[40:43], v14 offset:4096
    s_waitcnt lgkmcnt(5)
    v_mfma_f32_32x32x16_bf16 v[64:79], v[116:119], v[52:55], v[64:79]
    ds_read_b128 v[44:47], v15 offset:4096
    s_waitcnt lgkmcnt(5)
    v_mfma_f32_32x32x16_bf16 v[64:79], v[120:123], v[56:59], v[64:79]
    ds_read_b128 v[48:51], v12 offset:8192
    s_waitcnt lgkmcnt(5)
    v_mfma_f32_32x32x16_bf16 v[64:79], v[124:127], v[60:63], v[64:79]
    ds_read_b128 v[52:55], v13 offset:8192
    s_waitcnt lgkmcnt(5)
    v_mfma_f32_32x32x16_bf16 v[64:79], v[128:131], v[32:35], v[64:79]
    ds_read_b128 v[56:59], v14 offset:8192
    v_mul_f32 v96, s50, v96
    v_mul_f32 v97, s50, v97
    v_mul_f32 v98, s50, v98
    v_mul_f32 v99, s50, v99
    s_waitcnt lgkmcnt(5)
    v_mfma_f32_32x32x16_bf16 v[64:79], v[132:135], v[36:39], v[64:79]
    ds_read_b128 v[60:63], v15 offset:8192
    v_cvt_pk_bf16_f32 v24, v96, v97
    v_cvt_pk_bf16_f32 v25, v98, v99
    s_waitcnt lgkmcnt(5)
    v_mfma_f32_32x32x16_bf16 v[64:79], v[136:139], v[40:43], v[64:79]
    ds_read_b128 v[32:35], v12 offset:12288
    buffer_store_dwordx2 v[24:25], v16, s[40:43], s60 offen sc1
    v_mul_f32 v100, s50, v100
    v_mul_f32 v101, s50, v101
    s_waitcnt lgkmcnt(5)
    v_mfma_f32_32x32x16_bf16 v[64:79], v[140:143], v[44:47], v[64:79]
    ds_read_b128 v[36:39], v13 offset:12288
    v_mul_f32 v102, s50, v102
    v_mul_f32 v103, s50, v103
    v_cvt_pk_bf16_f32 v26, v100, v101
    s_waitcnt lgkmcnt(5)
    v_mfma_f32_32x32x16_bf16 v[64:79], v[144:147], v[48:51], v[64:79]
    ds_read_b128 v[40:43], v14 offset:12288
    v_cvt_pk_bf16_f32 v27, v102, v103
    buffer_store_dwordx2 v[26:27], v17, s[40:43], s60 offen sc1
    s_waitcnt lgkmcnt(5)
    v_mfma_f32_32x32x16_bf16 v[64:79], v[148:151], v[52:55], v[64:79]
    ds_read_b128 v[44:47], v15 offset:12288
    v_mul_f32 v104, s50, v104
    v_mul_f32 v105, s50, v105
    v_mul_f32 v106, s50, v106
    v_mul_f32 v107, s50, v107
    s_waitcnt lgkmcnt(5)
    v_mfma_f32_32x32x16_bf16 v[64:79], v[152:155], v[56:59], v[64:79]
    ds_read_b128 v[48:51], v12 offset:16384
    v_cvt_pk_bf16_f32 v28, v104, v105
    v_cvt_pk_bf16_f32 v29, v106, v107
    s_waitcnt lgkmcnt(5)
    v_mfma_f32_32x32x16_bf16 v[64:79], v[156:159], v[60:63], v[64:79]
    ds_read_b128 v[52:55], v13 offset:16384
    buffer_store_dwordx2 v[28:29], v18, s[40:43], s60 offen sc1
    v_mul_f32 v108, s50, v108
    v_mul_f32 v109, s50, v109
    s_waitcnt lgkmcnt(5)
    v_mfma_f32_32x32x16_bf16 v[64:79], v[160:163], v[32:35], v[64:79]
    ds_read_b128 v[56:59], v14 offset:16384
    v_mul_f32 v110, s50, v110
    v_mul_f32 v111, s50, v111
    v_cvt_pk_bf16_f32 v30, v108, v109
    s_waitcnt lgkmcnt(5)
    v_mfma_f32_32x32x16_bf16 v[64:79], v[164:167], v[36:39], v[64:79]
    ds_read_b128 v[60:63], v15 offset:16384
    v_cvt_pk_bf16_f32 v31, v110, v111
    buffer_store_dwordx2 v[30:31], v19, s[40:43], s60 offen sc1
    s_waitcnt lgkmcnt(5)
    v_mfma_f32_32x32x16_bf16 v[64:79], v[168:171], v[40:43], v[64:79]
    ds_read_b128 v[32:35], v12 offset:20480
    v_cndmask_b32 v96, v24, v30, s[54:55]
    buffer_store_dword v96, v20, s[40:43], s61 offen sc1
    s_waitcnt lgkmcnt(5)
    v_mfma_f32_32x32x16_bf16 v[64:79], v[172:175], v[44:47], v[64:79]
    ds_read_b128 v[36:39], v13 offset:20480
    buffer_store_dword v31, v21, s[40:43], s61 offen sc1
    s_waitcnt lgkmcnt(5)
    v_mfma_f32_32x32x16_bf16 v[64:79], v[176:179], v[48:51], v[64:79]
    ds_read_b128 v[40:43], v14 offset:20480
    s_waitcnt lgkmcnt(5)
    v_mfma_f32_32x32x16_bf16 v[64:79], v[180:183], v[52:55], v[64:79]
    ds_read_b128 v[44:47], v15 offset:20480
    s_waitcnt lgkmcnt(5)
    v_mfma_f32_32x32x16_bf16 v[64:79], v[184:187], v[56:59], v[64:79]
    ds_read_b128 v[48:51], v12 offset:24576
    s_waitcnt lgkmcnt(5)
    v_mfma_f32_32x32x16_bf16 v[64:79], v[188:191], v[60:63], v[64:79]
    ds_read_b128 v[52:55], v13 offset:24576
    s_waitcnt lgkmcnt(5)
    v_mfma_f32_32x32x16_bf16 v[64:79], v[192:195], v[32:35], v[64:79]
    ds_read_b128 v[56:59], v14 offset:24576
    s_waitcnt lgkmcnt(5)
    v_mfma_f32_32x32x16_bf16 v[64:79], v[196:199], v[36:39], v[64:79]
    ds_read_b128 v[60:63], v15 offset:24576
    s_waitcnt lgkmcnt(5)
    v_mfma_f32_32x32x16_bf16 v[64:79], v[200:203], v[40:43], v[64:79]
    ds_read_b128 v[32:35], v12 offset:28672
    s_waitcnt lgkmcnt(5)
    v_mfma_f32_32x32x16_bf16 v[64:79], v[204:207], v[44:47], v[64:79]
    ds_read_b128 v[36:39], v13 offset:28672
    s_waitcnt lgkmcnt(5)
    v_mfma_f32_32x32x16_bf16 v[64:79], v[208:211], v[48:51], v[64:79]
    ds_read_b128 v[40:43], v14 offset:28672
    s_waitcnt lgkmcnt(5)
    v_mfma_f32_32x32x16_bf16 v[64:79], v[212:215], v[52:55], v[64:79]
    ds_read_b128 v[44:47], v15 offset:28672
    s_waitcnt lgkmcnt(5)
    v_mfma_f32_32x32x16_bf16 v[64:79], v[216:219], v[56:59], v[64:79]
    ds_read_b128 v[48:51], v12 offset:32768
    s_waitcnt lgkmcnt(5)
    v_mfma_f32_32x32x16_bf16 v[64:79], v[220:223], v[60:63], v[64:79]
    ds_read_b128 v[52:55], v13 offset:32768
    s_waitcnt lgkmcnt(5)
    v_mfma_f32_32x32x16_bf16 v[64:79], v[224:227], v[32:35], v[64:79]
    ds_read_b128 v[56:59], v14 offset:32768
    s_waitcnt lgkmcnt(5)
    v_mfma_f32_32x32x16_bf16 v[64:79], v[228:231], v[36:39], v[64:79]
    ds_read_b128 v[60:63], v15 offset:32768
    s_cmp_eq_u32 s28, 12
    s_cbranch_scc1 K1_SHORT_Q
    v_add_u32 v12, 0, v8
    v_add_u32 v13, 0, v9
    v_add_u32 v14, 0, v10
    v_add_u32 v15, 0, v11
    s_barrier
    s_waitcnt lgkmcnt(5)
    v_mfma_f32_32x32x16_bf16 v[64:79], v[232:235], v[40:43], v[64:79]
    ds_read_b128 v[32:35], v12 offset:0
    s_waitcnt lgkmcnt(5)
    v_mfma_f32_32x32x16_bf16 v[64:79], v[236:239], v[44:47], v[64:79]
    ds_read_b128 v[36:39], v13 offset:0
    s_waitcnt lgkmcnt(5)
    v_mfma_f32_32x32x16_bf16 v[64:79], v[240:243], v[48:51], v[64:79]
    ds_read_b128 v[40:43], v14 offset:0
    s_waitcnt lgkmcnt(5)
    v_mfma_f32_32x32x16_bf16 v[64:79], v[244:247], v[52:55], v[64:79]
    ds_read_b128 v[44:47], v15 offset:0
    s_waitcnt lgkmcnt(5)
    v_mfma_f32_32x32x16_bf16 v[64:79], v[248:251], v[56:59], v[64:79]
    ds_read_b128 v[48:51], v12 offset:4096
    s_waitcnt lgkmcnt(5)
    v_mfma_f32_32x32x16_bf16 v[64:79], v[252:255], v[60:63], v[64:79]
    ds_read_b128 v[52:55], v13 offset:4096
    s_waitcnt lgkmcnt(5)
    v_mfma_f32_32x32x16_bf16 v[80:95], v[112:115], v[32:35], 0
    ds_read_b128 v[56:59], v14 offset:4096
    s_waitcnt lgkmcnt(5)
    v_mfma_f32_32x32x16_bf16 v[80:95], v[116:119], v[36:39], v[80:95]
    ds_read_b128 v[60:63], v15 offset:4096
    s_waitcnt lgkmcnt(5)
    v_mfma_f32_32x32x16_bf16 v[80:95], v[120:123], v[40:43], v[80:95]
    ds_read_b128 v[32:35], v12 offset:8192
    s_waitcnt vmcnt(0)
    buffer_store_dword v23, v22, s[40:43], s70 offen sc1
    s_waitcnt lgkmcnt(5)
    v_mfma_f32_32x32x16_bf16 v[80:95], v[124:127], v[44:47], v[80:95]
    ds_read_b128 v[36:39], v13 offset:8192
    s_waitcnt lgkmcnt(5)
    v_mfma_f32_32x32x16_bf16 v[80:95], v[128:131], v[48:51], v[80:95]
    ds_read_b128 v[40:43], v14 offset:8192
    v_mul_f32 v64, s50, v64
    v_mul_f32 v65, s50, v65
    s_waitcnt lgkmcnt(5)
    v_mfma_f32_32x32x16_bf16 v[80:95], v[132:135], v[52:55], v[80:95]
    ds_read_b128 v[44:47], v15 offset:8192
    v_mul_f32 v66, s50, v66
    v_mul_f32 v67, s50, v67
    s_waitcnt lgkmcnt(5)
    v_mfma_f32_32x32x16_bf16 v[80:95], v[136:139], v[56:59], v[80:95]
    ds_read_b128 v[48:51], v12 offset:12288
    v_cvt_pk_bf16_f32 v24, v64, v65
    s_waitcnt lgkmcnt(5)
    v_mfma_f32_32x32x16_bf16 v[80:95], v[140:143], v[60:63], v[80:95]
    ds_read_b128 v[52:55], v13 offset:12288
    v_cvt_pk_bf16_f32 v25, v66, v67
    s_waitcnt lgkmcnt(5)
    v_mfma_f32_32x32x16_bf16 v[80:95], v[144:147], v[32:35], v[80:95]
    ds_read_b128 v[56:59], v14 offset:12288
    buffer_store_dwordx2 v[24:25], v16, s[40:43], s62 offen sc1
    s_waitcnt lgkmcnt(5)
    v_mfma_f32_32x32x16_bf16 v[80:95], v[148:151], v[36:39], v[80:95]
    ds_read_b128 v[60:63], v15 offset:12288
    v_mul_f32 v68, s50, v68
    v_mul_f32 v69, s50, v69
    s_waitcnt lgkmcnt(5)
    v_mfma_f32_32x32x16_bf16 v[80:95], v[152:155], v[40:43], v[80:95]
    ds_read_b128 v[32:35], v12 offset:16384
    v_mul_f32 v70, s50, v70
    v_mul_f32 v71, s50, v71
    s_waitcnt lgkmcnt(5)
    v_mfma_f32_32x32x16_bf16 v[80:95], v[156:159], v[44:47], v[80:95]
    ds_read_b128 v[36:39], v13 offset:16384
    v_cvt_pk_bf16_f32 v26, v68, v69
    s_waitcnt lgkmcnt(5)
    v_mfma_f32_32x32x16_bf16 v[80:95], v[160:163], v[48:51], v[80:95]
    ds_read_b128 v[40:43], v14 offset:16384
    v_cvt_pk_bf16_f32 v27, v70, v71
    s_waitcnt lgkmcnt(5)
    v_mfma_f32_32x32x16_bf16 v[80:95], v[164:167], v[52:55], v[80:95]
    ds_read_b128 v[44:47], v15 offset:16384
    buffer_store_dwordx2 v[26:27], v17, s[40:43], s62 offen sc1
    s_waitcnt lgkmcnt(5)
    v_mfma_f32_32x32x16_bf16 v[80:95], v[168:171], v[56:59], v[80:95]
    ds_read_b128 v[48:51], v12 offset:20480
    v_mul_f32 v72, s50, v72
    v_mul_f32 v73, s50, v73
    s_waitcnt lgkmcnt(5)
    v_mfma_f32_32x32x16_bf16 v[80:95], v[172:175], v[60:63], v[80:95]
    ds_read_b128 v[52:55], v13 offset:20480
    v_mul_f32 v74, s50, v74
    v_mul_f32 v75, s50, v75
    s_waitcnt lgkmcnt(5)
    v_mfma_f32_32x32x16_bf16 v[80:95], v[176:179], v[32:35], v[80:95]
    ds_read_b128 v[56:59], v14 offset:20480
    v_cvt_pk_bf16_f32 v28, v72, v73
    s_waitcnt lgkmcnt(5)
    v_mfma_f32_32x32x16_bf16 v[80:95], v[180:183], v[36:39], v[80:95]
    ds_read_b128 v[60:63], v15 offset:20480
    v_cvt_pk_bf16_f32 v29, v74, v75
    s_waitcnt lgkmcnt(5)
    v_mfma_f32_32x32x16_bf16 v[80:95], v[184:187], v[40:43], v[80:95]
    ds_read_b128 v[32:35], v12 offset:24576
    buffer_store_dwordx2 v[28:29], v18, s[40:43], s62 offen sc1
    s_waitcnt lgkmcnt(5)
    v_mfma_f32_32x32x16_bf16 v[80:95], v[188:191], v[44:47], v[80:95]
    ds_read_b128 v[36:39], v13 offset:24576
    v_mul_f32 v76, s50, v76
    v_mul_f32 v77, s50, v77
    s_waitcnt lgkmcnt(5)
    v_mfma_f32_32x32x16_bf16 v[80:95], v[192:195], v[48:51], v[80:95]
    ds_read_b128 v[40:43], v14 offset:24576
    v_mul_f32 v78, s50, v78
    v_mul_f32 v79, s50, v79
    s_waitcnt lgkmcnt(5)
    v_mfma_f32_32x32x16_bf16 v[80:95], v[196:199], v[52:55], v[80:95]
    ds_read_b128 v[44:47], v15 offset:24576
    v_cvt_pk_bf16_f32 v30, v76, v77
    s_waitcnt lgkmcnt(5)
    v_mfma_f32_32x32x16_bf16 v[80:95], v[200:203], v[56:59], v[80:95]
    ds_read_b128 v[48:51], v12 offset:28672
    v_cvt_pk_bf16_f32 v31, v78, v79
    s_waitcnt lgkmcnt(5)
    v_mfma_f32_32x32x16_bf16 v[80:95], v[204:207], v[60:63], v[80:95]
    ds_read_b128 v[52:55], v13 offset:28672
    buffer_store_dwordx2 v[30:31], v19, s[40:43], s62 offen sc1
    s_waitcnt lgkmcnt(5)
    v_mfma_f32_32x32x16_bf16 v[80:95], v[208:211], v[32:35], v[80:95]
    ds_read_b128 v[56:59], v14 offset:28672
    v_cndmask_b32 v64, v24, v30, s[54:55]
    s_waitcnt lgkmcnt(5)
    v_mfma_f32_32x32x16_bf16 v[80:95], v[212:215], v[36:39], v[80:95]
    ds_read_b128 v[60:63], v15 offset:28672
    buffer_store_dword v64, v20, s[40:43], s63 offen sc1
    s_waitcnt lgkmcnt(5)
    v_mfma_f32_32x32x16_bf16 v[80:95], v[216:219], v[40:43], v[80:95]
    ds_read_b128 v[32:35], v12 offset:32768
    buffer_store_dword v31, v21, s[40:43], s63 offen sc1
    s_waitcnt lgkmcnt(5)
    v_mfma_f32_32x32x16_bf16 v[80:95], v[220:223], v[44:47], v[80:95]
    ds_read_b128 v[36:39], v13 offset:32768
    s_waitcnt lgkmcnt(5)
    v_mfma_f32_32x32x16_bf16 v[80:95], v[224:227], v[48:51], v[80:95]
    ds_read_b128 v[40:43], v14 offset:32768
    s_waitcnt lgkmcnt(5)
    v_mfma_f32_32x32x16_bf16 v[80:95], v[228:231], v[52:55], v[80:95]
    ds_read_b128 v[44:47], v15 offset:32768
    s_waitcnt lgkmcnt(5)
    v_mfma_f32_32x32x16_bf16 v[80:95], v[232:235], v[56:59], v[80:95]
    s_waitcnt lgkmcnt(4)
    v_mfma_f32_32x32x16_bf16 v[80:95], v[236:239], v[60:63], v[80:95]
    s_waitcnt lgkmcnt(3)
    v_mfma_f32_32x32x16_bf16 v[80:95], v[240:243], v[32:35], v[80:95]
    s_waitcnt lgkmcnt(2)
    v_mfma_f32_32x32x16_bf16 v[80:95], v[244:247], v[36:39], v[80:95]
    s_waitcnt lgkmcnt(1)
    v_mfma_f32_32x32x16_bf16 v[80:95], v[248:251], v[40:43], v[80:95]
    s_waitcnt lgkmcnt(0)
    v_mfma_f32_32x32x16_bf16 v[80:95], v[252:255], v[44:47], v[80:95]
    s_nop 11
    v_mul_f32 v80, s50, v80
    v_mul_f32 v81, s50, v81
    v_mul_f32 v82, s50, v82
    v_mul_f32 v83, s50, v83
    v_cvt_pk_bf16_f32 v24, v80, v81
    v_cvt_pk_bf16_f32 v25, v82, v83
    buffer_store_dwordx2 v[24:25], v16, s[40:43], s64 offen sc1
    v_mul_f32 v84, s50, v84
    v_mul_f32 v85, s50, v85
    v_mul_f32 v86, s50, v86
    v_mul_f32 v87, s50, v87
    v_cvt_pk_bf16_f32 v26, v84, v85
    v_cvt_pk_bf16_f32 v27, v86, v87
    buffer_store_dwordx2 v[26:27], v17, s[40:43], s64 offen sc1
    v_mul_f32 v88, s50, v88
    v_mul_f32 v89, s50, v89
    v_mul_f32 v90, s50, v90
    v_mul_f32 v91, s50, v91
    v_cvt_pk_bf16_f32 v28, v88, v89
    v_cvt_pk_bf16_f32 v29, v90, v91
    buffer_store_dwordx2 v[28:29], v18, s[40:43], s64 offen sc1
    v_mul_f32 v92, s50, v92
    v_mul_f32 v93, s50, v93
    v_mul_f32 v94, s50, v94
    v_mul_f32 v95, s50, v95
    v_cvt_pk_bf16_f32 v30, v92, v93
    v_cvt_pk_bf16_f32 v31, v94, v95
    buffer_store_dwordx2 v[30:31], v19, s[40:43], s64 offen sc1
    v_cndmask_b32 v80, v24, v30, s[54:55]
    buffer_store_dword v80, v20, s[40:43], s65 offen sc1
    buffer_store_dword v31, v21, s[40:43], s65 offen sc1
    s_branch K1_CDONE
K1_SHORT_Q:
    s_waitcnt lgkmcnt(0)
    v_mfma_f32_32x32x16_bf16 v[64:79], v[232:235], v[40:43], v[64:79]
    v_mfma_f32_32x32x16_bf16 v[64:79], v[236:239], v[44:47], v[64:79]
    v_mfma_f32_32x32x16_bf16 v[64:79], v[240:243], v[48:51], v[64:79]
    v_mfma_f32_32x32x16_bf16 v[64:79], v[244:247], v[52:55], v[64:79]
    v_mfma_f32_32x32x16_bf16 v[64:79], v[248:251], v[56:59], v[64:79]
    v_mfma_f32_32x32x16_bf16 v[64:79], v[252:255], v[60:63], v[64:79]
    s_waitcnt vmcnt(0)
    buffer_store_dword v23, v22, s[40:43], s70 offen sc1
    s_nop 9
    v_mul_f32 v64, s50, v64
    v_mul_f32 v65, s50, v65
    v_mul_f32 v66, s50, v66
    v_mul_f32 v67, s50, v67
    v_cvt_pk_bf16_f32 v24, v64, v65
    v_cvt_pk_bf16_f32 v25, v66, v67
    buffer_store_dwordx2 v[24:25], v16, s[40:43], s62 offen sc1
    v_mul_f32 v68, s50, v68
    v_mul_f32 v69, s50, v69
    v_mul_f32 v70, s50, v70
    v_mul_f32 v71, s50, v71
    v_cvt_pk_bf16_f32 v26, v68, v69
    v_cvt_pk_bf16_f32 v27, v70, v71
    buffer_store_dwordx2 v[26:27], v17, s[40:43], s62 offen sc1
    v_mul_f32 v72, s50, v72
    v_mul_f32 v73, s50, v73
    v_mul_f32 v74, s50, v74
    v_mul_f32 v75, s50, v75
    v_cvt_pk_bf16_f32 v28, v72, v73
    v_cvt_pk_bf16_f32 v29, v74, v75
    buffer_store_dwordx2 v[28:29], v18, s[40:43], s62 offen sc1
    v_mul_f32 v76, s50, v76
    v_mul_f32 v77, s50, v77
    v_mul_f32 v78, s50, v78
    v_mul_f32 v79, s50, v79
    v_cvt_pk_bf16_f32 v30, v76, v77
    v_cvt_pk_bf16_f32 v31, v78, v79
    buffer_store_dwordx2 v[30:31], v19, s[40:43], s62 offen sc1
    v_cndmask_b32 v64, v24, v30, s[54:55]
    buffer_store_dword v64, v20, s[40:43], s63 offen sc1
    buffer_store_dword v31, v21, s[40:43], s63 offen sc1
    s_branch K1_CDONE
K1_VTYPE:
    v_and_b32 v40, 0x13, v1
    v_bfe_u32 v41, v1, 2, 1
    v_lshl_or_b32 v40, v41, 3, v40
    v_bfe_u32 v41, v1, 3, 1
    v_lshl_or_b32 v40, v41, 2, v40
    v_lshl_add_u32 v6, v4, 3, v6
    v_bfe_u32 v41, v40, 1, 3
    v_xor_b32 v41, v41, v2
    v_lshlrev_b32 v41, 4, v41
    v_lshl_add_u32 v8, v40, 7, v41
    v_xor_b32 v9, 32, v8
    v_xor_b32 v10, 64, v8
    v_xor_b32 v11, 96, v8
    s_cmp_eq_u32 s30, 73
    s_cselect_b32 s36, 18, s32
    s_lshl_b32 s36, s36, 9
    s_add_u32 s36, s36, 2555904
    s_mul_i32 s34, s28, 116736
    s_add_u32 s34, s34, 0
    s_add_u32 s56, s34, s36
    s_add_u32 s57, s56, 19456
    s_mul_i32 s34, s28, 116736
    s_add_u32 s34, s34, 38912
    s_add_u32 s58, s34, s36
    s_add_u32 s59, s58, 19456
    s_mul_i32 s34, s28, 116736
    s_add_u32 s34, s34, 77824
    s_add_u32 s60, s34, s36
    s_add_u32 s61, s60, 19456
    s_mul_i32 s34, s28, 77824
    s_add_u32 s34, s34, 1517568
    s_add_u32 s62, s34, s36
    s_add_u32 s63, s62, 19456
    s_mul_i32 s34, s28, 77824
    s_add_u32 s34, s34, 1556480
    s_add_u32 s64, s34, s36
    s_add_u32 s65, s64, 19456
    v_mul_u32_u24 v43, 9728, v2
    v_lshl_add_u32 v16, v1, 4, v43
    v_cmp_eq_u32 s[54:55], 16, v1
    v_mov_b32 v20, 0x3f803f80
    s_setprio 1
    v_add_u32 v12, 0, v8
    v_add_u32 v13, 0, v9
    v_add_u32 v14, 0, v10
    v_add_u32 v15, 0, v11
    v_add_u32 v7, 0, v6
    s_barrier
    buffer_load_dword v31, v30, s[20:23], 0 offen
    ds_read_b64_tr_b16 v[112:113], v7 offset:0
    ds_read_b64_tr_b16 v[114:115], v7 offset:1024
    ds_read_b128 v[32:35], v12 offset:16384
    ds_read_b128 v[36:39], v12 offset:20480
    ds_read_b64_tr_b16 v[116:117], v7 offset:4096
    ds_read_b64_tr_b16 v[118:119], v7 offset:5120
    ds_read_b128 v[40:43], v13 offset:16384
    ds_read_b128 v[44:47], v13 offset:20480
    ds_read_b64_tr_b16 v[120:121], v7 offset:8192
    ds_read_b64_tr_b16 v[122:123], v7 offset:9216
    ds_read_b128 v[48:51], v14 offset:16384
    ds_read_b128 v[52:55], v14 offset:20480
    s_waitcnt lgkmcnt(8)
    ds_read_b64_tr_b16 v[124:125], v7 offset:12288
    ds_read_b64_tr_b16 v[126:127], v7 offset:13312
    v_mfma_f32_32x32x16_bf16 v[64:79], v[32:35], v[112:115], 0
    ds_read_b128 v[56:59], v15 offset:16384
    ds_read_b128 v[60:63], v15 offset:20480
    v_mfma_f32_32x32x16_bf16 v[80:95], v[36:39], v[112:115], 0
    s_waitcnt lgkmcnt(8)
    v_add_u32 v12, 24576, v8
    v_add_u32 v13, 24576, v9
    v_add_u32 v14, 24576, v10
    v_add_u32 v15, 24576, v11
    v_add_u32 v7, 24576, v6
    s_barrier
    ds_read_b64_tr_b16 v[128:129], v7 offset:0
    ds_read_b64_tr_b16 v[130:131], v7 offset:1024
    v_mfma_f32_32x32x16_bf16 v[64:79], v[40:43], v[116:119], v[64:79]
    ds_read_b128 v[32:35], v12 offset:16384
    ds_read_b128 v[36:39], v12 offset:20480
    v_mfma_f32_32x32x16_bf16 v[80:95], v[44:47], v[116:119], v[80:95]
    s_waitcnt lgkmcnt(8)
    ds_read_b64_tr_b16 v[132:133], v7 offset:4096
    ds_read_b64_tr_b16 v[134:135], v7 offset:5120
    v_mfma_f32_32x32x16_bf16 v[64:79], v[48:51], v[120:123], v[64:79]
    ds_read_b128 v[40:43], v13 offset:16384
    ds_read_b128 v[44:47], v13 offset:20480
    v_mfma_f32_32x32x16_bf16 v[80:95], v[52:55], v[120:123], v[80:95]
    s_waitcnt lgkmcnt(8)
    ds_read_b64_tr_b16 v[136:137], v7 offset:8192
    ds_read_b64_tr_b16 v[138:139], v7 offset:9216
    v_mfma_f32_32x32x16_bf16 v[64:79], v[56:59], v[124:127], v[64:79]
    ds_read_b128 v[48:51], v14 offset:16384
    ds_read_b128 v[52:55], v14 offset:20480
    v_mfma_f32_32x32x16_bf16 v[80:95], v[60:63], v[124:127], v[80:95]
    s_waitcnt lgkmcnt(8)
    ds_read_b64_tr_b16 v[140:141], v7 offset:12288
    ds_read_b64_tr_b16 v[142:143], v7 offset:13312
    v_mfma_f32_32x32x16_bf16 v[64:79], v[32:35], v[128:131], v[64:79]
    ds_read_b128 v[56:59], v15 offset:16384
    ds_read_b128 v[60:63], v15 offset:20480
    v_mfma_f32_32x32x16_bf16 v[80:95], v[36:39], v[128:131], v[80:95]
    s_waitcnt lgkmcnt(8)
    v_add_u32 v12, 49152, v8
    v_add_u32 v13, 49152, v9
    v_add_u32 v14, 49152, v10
    v_add_u32 v15, 49152, v11
    v_add_u32 v7, 49152, v6
    s_barrier
    ds_read_b64_tr_b16 v[144:145], v7 offset:0
    ds_read_b64_tr_b16 v[146:147], v7 offset:1024
    v_mfma_f32_32x32x16_bf16 v[64:79], v[40:43], v[132:135], v[64:79]
    ds_read_b128 v[32:35], v12 offset:16384
    ds_read_b128 v[36:39], v12 offset:20480
    v_mfma_f32_32x32x16_bf16 v[80:95], v[44:47], v[132:135], v[80:95]
    s_waitcnt lgkmcnt(8)
    ds_read_b64_tr_b16 v[148:149], v7 offset:4096
    ds_read_b64_tr_b16 v[150:151], v7 offset:5120
    v_mfma_f32_32x32x16_bf16 v[64:79], v[48:51], v[136:139], v[64:79]
    ds_read_b128 v[40:43], v13 offset:16384
    ds_read_b128 v[44:47], v13 offset:20480
    v_mfma_f32_32x32x16_bf16 v[80:95], v[52:55], v[136:139], v[80:95]
    s_waitcnt lgkmcnt(8)
    ds_read_b64_tr_b16 v[152:153], v7 offset:8192
    ds_read_b64_tr_b16 v[154:155], v7 offset:9216
    v_mfma_f32_32x32x16_bf16 v[64:79], v[56:59], v[140:143], v[64:79]
    ds_read_b128 v[48:51], v14 offset:16384
    ds_read_b128 v[52:55], v14 offset:20480
    v_mfma_f32_32x32x16_bf16 v[80:95], v[60:63], v[140:143], v[80:95]
    s_waitcnt lgkmcnt(8)
    ds_read_b64_tr_b16 v[156:157], v7 offset:12288
    ds_read_b64_tr_b16 v[158:159], v7 offset:13312
    v_mfma_f32_32x32x16_bf16 v[64:79], v[32:35], v[144:147], v[64:79]
    ds_read_b128 v[56:59], v15 offset:16384
    ds_read_b128 v[60:63], v15 offset:20480
    v_mfma_f32_32x32x16_bf16 v[80:95], v[36:39], v[144:147], v[80:95]
    s_waitcnt lgkmcnt(8)
    v_add_u32 v12, 73728, v8
    v_add_u32 v13, 73728, v9
    v_add_u32 v14, 73728, v10
    v_add_u32 v15, 73728, v11
    v_add_u32 v7, 73728, v6
    s_barrier
    ds_read_b64_tr_b16 v[160:161], v7 offset:0
    ds_read_b64_tr_b16 v[162:163], v7 offset:1024
    v_mfma_f32_32x32x16_bf16 v[64:79], v[40:43], v[148:151], v[64:79]
    ds_read_b128 v[32:35], v12 offset:16384
    ds_read_b128 v[36:39], v12 offset:20480
    v_mfma_f32_32x32x16_bf16 v[80:95], v[44:47], v[148:151], v[80:95]
    s_waitcnt lgkmcnt(8)
    ds_read_b64_tr_b16 v[164:165], v7 offset:4096
    ds_read_b64_tr_b16 v[166:167], v7 offset:5120
    v_mfma_f32_32x32x16_bf16 v[64:79], v[48:51], v[152:155], v[64:79]
    ds_read_b128 v[40:43], v13 offset:16384
    ds_read_b128 v[44:47], v13 offset:20480
    v_mfma_f32_32x32x16_bf16 v[80:95], v[52:55], v[152:155], v[80:95]
    s_waitcnt lgkmcnt(8)
    ds_read_b64_tr_b16 v[168:169], v7 offset:8192
    ds_read_b64_tr_b16 v[170:171], v7 offset:9216
    v_mfma_f32_32x32x16_bf16 v[64:79], v[56:59], v[156:159], v[64:79]
    ds_read_b128 v[48:51], v14 offset:16384
    ds_read_b128 v[52:55], v14 offset:20480
    v_mfma_f32_32x32x16_bf16 v[80:95], v[60:63], v[156:159], v[80:95]
    s_waitcnt lgkmcnt(8)
    ds_read_b64_tr_b16 v[172:173], v7 offset:12288
    ds_read_b64_tr_b16 v[174:175], v7 offset:13312
    v_mfma_f32_32x32x16_bf16 v[64:79], v[32:35], v[160:163], v[64:79]
    ds_read_b128 v[56:59], v15 offset:16384
    ds_read_b128 v[60:63], v15 offset:20480
    v_mfma_f32_32x32x16_bf16 v[80:95], v[36:39], v[160:163], v[80:95]
    s_waitcnt lgkmcnt(8)
    v_add_u32 v12, 98304, v8
    v_add_u32 v13, 98304, v9
    v_add_u32 v14, 98304, v10
    v_add_u32 v15, 98304, v11
    v_add_u32 v7, 98304, v6
    s_barrier
    ds_read_b64_tr_b16 v[176:177], v7 offset:0
    ds_read_b64_tr_b16 v[178:179], v7 offset:1024
    v_mfma_f32_32x32x16_bf16 v[64:79], v[40:43], v[164:167], v[64:79]
    ds_read_b128 v[32:35], v12 offset:16384
    ds_read_b128 v[36:39], v12 offset:20480
    v_mfma_f32_32x32x16_bf16 v[80:95], v[44:47], v[164:167], v[80:95]
    s_waitcnt lgkmcnt(8)
    ds_read_b64_tr_b16 v[180:181], v7 offset:4096
    ds_read_b64_tr_b16 v[182:183], v7 offset:5120
    v_mfma_f32_32x32x16_bf16 v[64:79], v[48:51], v[168:171], v[64:79]
    ds_read_b128 v[40:43], v13 offset:16384
    ds_read_b128 v[44:47], v13 offset:20480
    v_mfma_f32_32x32x16_bf16 v[80:95], v[52:55], v[168:171], v[80:95]
    s_waitcnt lgkmcnt(8)
    ds_read_b64_tr_b16 v[184:185], v7 offset:8192
    ds_read_b64_tr_b16 v[186:187], v7 offset:9216
    v_mfma_f32_32x32x16_bf16 v[64:79], v[56:59], v[172:175], v[64:79]
    ds_read_b128 v[48:51], v14 offset:16384
    ds_read_b128 v[52:55], v14 offset:20480
    v_mfma_f32_32x32x16_bf16 v[80:95], v[60:63], v[172:175], v[80:95]
    s_waitcnt lgkmcnt(8)
    ds_read_b64_tr_b16 v[188:189], v7 offset:12288
    ds_read_b64_tr_b16 v[190:191], v7 offset:13312
    v_mfma_f32_32x32x16_bf16 v[64:79], v[32:35], v[176:179], v[64:79]
    ds_read_b128 v[56:59], v15 offset:16384
    ds_read_b128 v[60:63], v15 offset:20480
    v_mfma_f32_32x32x16_bf16 v[80:95], v[36:39], v[176:179], v[80:95]
    s_waitcnt lgkmcnt(8)
    v_add_u32 v12, 122880, v8
    v_add_u32 v13, 122880, v9
    v_add_u32 v14, 122880, v10
    v_add_u32 v15, 122880, v11
    v_add_u32 v7, 122880, v6
    s_barrier
    ds_read_b64_tr_b16 v[192:193], v7 offset:0
    ds_read_b64_tr_b16 v[194:195], v7 offset:1024
    v_mfma_f32_32x32x16_bf16 v[64:79], v[40:43], v[180:183], v[64:79]
    ds_read_b128 v[32:35], v12 offset:16384
    ds_read_b128 v[36:39], v12 offset:20480
    v_mfma_f32_32x32x16_bf16 v[80:95], v[44:47], v[180:183], v[80:95]
    s_waitcnt lgkmcnt(8)
    ds_read_b64_tr_b16 v[196:197], v7 offset:4096
    ds_read_b64_tr_b16 v[198:199], v7 offset:5120
    v_mfma_f32_32x32x16_bf16 v[64:79], v[48:51], v[184:187], v[64:79]
    ds_read_b128 v[40:43], v13 offset:16384
    ds_read_b128 v[44:47], v13 offset:20480
    v_mfma_f32_32x32x16_bf16 v[80:95], v[52:55], v[184:187], v[80:95]
    s_waitcnt lgkmcnt(8)
    ds_read_b64_tr_b16 v[200:201], v7 offset:8192
    ds_read_b64_tr_b16 v[202:203], v7 offset:9216
    v_mfma_f32_32x32x16_bf16 v[64:79], v[56:59], v[188:191], v[64:79]
    ds_read_b128 v[48:51], v14 offset:16384
    ds_read_b128 v[52:55], v14 offset:20480
    v_mfma_f32_32x32x16_bf16 v[80:95], v[60:63], v[188:191], v[80:95]
    s_waitcnt lgkmcnt(8)
    ds_read_b64_tr_b16 v[204:205], v7 offset:12288
    ds_read_b64_tr_b16 v[206:207], v7 offset:13312
    v_mfma_f32_32x32x16_bf16 v[64:79], v[32:35], v[192:195], v[64:79]
    ds_read_b128 v[56:59], v15 offset:16384
    ds_read_b128 v[60:63], v15 offset:20480
    v_mfma_f32_32x32x16_bf16 v[80:95], v[36:39], v[192:195], v[80:95]
    s_waitcnt lgkmcnt(8)
    v_add_u32 v12, 0, v8
    v_add_u32 v13, 0, v9
    v_add_u32 v14, 0, v10
    v_add_u32 v15, 0, v11
    v_add_u32 v7, 0, v6
    s_barrier
    ds_read_b64_tr_b16 v[208:209], v7 offset:0
    ds_read_b64_tr_b16 v[210:211], v7 offset:1024
    v_mfma_f32_32x32x16_bf16 v[64:79], v[40:43], v[196:199], v[64:79]
    ds_read_b128 v[32:35], v12 offset:16384
    ds_read_b128 v[36:39], v12 offset:20480
    v_mfma_f32_32x32x16_bf16 v[80:95], v[44:47], v[196:199], v[80:95]
    s_waitcnt lgkmcnt(8)
    ds_read_b64_tr_b16 v[212:213], v7 offset:4096
    ds_read_b64_tr_b16 v[214:215], v7 offset:5120
    v_mfma_f32_32x32x16_bf16 v[64:79], v[48:51], v[200:203], v[64:79]
    ds_read_b128 v[40:43], v13 offset:16384
    ds_read_b128 v[44:47], v13 offset:20480
    v_mfma_f32_32x32x16_bf16 v[80:95], v[52:55], v[200:203], v[80:95]
    s_waitcnt lgkmcnt(8)
    ds_read_b64_tr_b16 v[216:217], v7 offset:8192
    ds_read_b64_tr_b16 v[218:219], v7 offset:9216
    v_mfma_f32_32x32x16_bf16 v[64:79], v[56:59], v[204:207], v[64:79]
    ds_read_b128 v[48:51], v14 offset:16384
    ds_read_b128 v[52:55], v14 offset:20480
    v_mfma_f32_32x32x16_bf16 v[80:95], v[60:63], v[204:207], v[80:95]
    s_waitcnt lgkmcnt(8)
    ds_read_b64_tr_b16 v[220:221], v7 offset:12288
    ds_read_b64_tr_b16 v[222:223], v7 offset:13312
    v_mfma_f32_32x32x16_bf16 v[64:79], v[32:35], v[208:211], v[64:79]
    ds_read_b128 v[56:59], v15 offset:16384
    ds_read_b128 v[60:63], v15 offset:20480
    v_mfma_f32_32x32x16_bf16 v[80:95], v[36:39], v[208:211], v[80:95]
    buffer_load_dword v23, v28, s[24:27], 0 offen sc1
    s_waitcnt lgkmcnt(8)
    v_add_u32 v12, 24576, v8
    v_add_u32 v13, 24576, v9
    v_add_u32 v14, 24576, v10
    v_add_u32 v15, 24576, v11
    v_add_u32 v7, 24576, v6
    s_barrier
    ds_read_b64_tr_b16 v[224:225], v7 offset:0
    ds_read_b64_tr_b16 v[226:227], v7 offset:1024
    v_mfma_f32_32x32x16_bf16 v[64:79], v[40:43], v[212:215], v[64:79]
    ds_read_b128 v[32:35], v12 offset:16384
    ds_read_b128 v[36:39], v12 offset:20480
    v_mfma_f32_32x32x16_bf16 v[80:95], v[44:47], v[212:215], v[80:95]
    s_waitcnt lgkmcnt(8)
    ds_read_b64_tr_b16 v[228:229], v7 offset:4096
    ds_read_b64_tr_b16 v[230:231], v7 offset:5120
    v_mfma_f32_32x32x16_bf16 v[64:79], v[48:51], v[216:219], v[64:79]
    ds_read_b128 v[40:43], v13 offset:16384
    ds_read_b128 v[44:47], v13 offset:20480
    v_mfma_f32_32x32x16_bf16 v[80:95], v[52:55], v[216:219], v[80:95]
    s_waitcnt lgkmcnt(8)
    ds_read_b64_tr_b16 v[232:233], v7 offset:8192
    ds_read_b64_tr_b16 v[234:235], v7 offset:9216
    v_mfma_f32_32x32x16_bf16 v[64:79], v[56:59], v[220:223], v[64:79]
    ds_read_b128 v[48:51], v14 offset:16384
    ds_read_b128 v[52:55], v14 offset:20480
    v_mfma_f32_32x32x16_bf16 v[80:95], v[60:63], v[220:223], v[80:95]
    s_waitcnt lgkmcnt(8)
    ds_read_b64_tr_b16 v[236:237], v7 offset:12288
    ds_read_b64_tr_b16 v[238:239], v7 offset:13312
    v_mfma_f32_32x32x16_bf16 v[64:79], v[32:35], v[224:227], v[64:79]
    ds_read_b128 v[56:59], v15 offset:16384
    ds_read_b128 v[60:63], v15 offset:20480
    v_mfma_f32_32x32x16_bf16 v[80:95], v[36:39], v[224:227], v[80:95]
    s_waitcnt lgkmcnt(8)
    v_add_u32 v12, 49152, v8
    v_add_u32 v13, 49152, v9
    v_add_u32 v14, 49152, v10
    v_add_u32 v15, 49152, v11
    v_add_u32 v7, 49152, v6
    s_barrier
    ds_read_b64_tr_b16 v[240:241], v7 offset:0
    ds_read_b64_tr_b16 v[242:243], v7 offset:1024
    v_mfma_f32_32x32x16_bf16 v[64:79], v[40:43], v[228:231], v[64:79]
    ds_read_b128 v[32:35], v12 offset:16384
    ds_read_b128 v[36:39], v12 offset:20480
    v_mfma_f32_32x32x16_bf16 v[80:95], v[44:47], v[228:231], v[80:95]
    s_waitcnt lgkmcnt(8)
    ds_read_b64_tr_b16 v[244:245], v7 offset:4096
    ds_read_b64_tr_b16 v[246:247], v7 offset:5120
    v_mfma_f32_32x32x16_bf16 v[64:79], v[48:51], v[232:235], v[64:79]
    ds_read_b128 v[40:43], v13 offset:16384
    ds_read_b128 v[44:47], v13 offset:20480
    v_mfma_f32_32x32x16_bf16 v[80:95], v[52:55], v[232:235], v[80:95]
    s_waitcnt lgkmcnt(8)
    ds_read_b64_tr_b16 v[248:249], v7 offset:8192
    ds_read_b64_tr_b16 v[250:251], v7 offset:9216
    v_mfma_f32_32x32x16_bf16 v[64:79], v[56:59], v[236:239], v[64:79]
    ds_read_b128 v[48:51], v14 offset:16384
    ds_read_b128 v[52:55], v14 offset:20480
    v_mfma_f32_32x32x16_bf16 v[80:95], v[60:63], v[236:239], v[80:95]
    s_waitcnt lgkmcnt(8)
    ds_read_b64_tr_b16 v[252:253], v7 offset:12288
    ds_read_b64_tr_b16 v[254:255], v7 offset:13312
    v_mfma_f32_32x32x16_bf16 v[64:79], v[32:35], v[240:243], v[64:79]
    ds_read_b128 v[56:59], v15 offset:16384
    ds_read_b128 v[60:63], v15 offset:20480
    v_mfma_f32_32x32x16_bf16 v[80:95], v[36:39], v[240:243], v[80:95]
    s_waitcnt lgkmcnt(8)
    v_add_u32 v12, 73728, v8
    v_add_u32 v13, 73728, v9
    v_add_u32 v14, 73728, v10
    v_add_u32 v15, 73728, v11
    s_barrier
    ds_read_b128 v[32:35], v12 offset:0
    ds_read_b128 v[36:39], v13 offset:0
    v_mfma_f32_32x32x16_bf16 v[64:79], v[40:43], v[244:247], v[64:79]
    v_mfma_f32_32x32x16_bf16 v[80:95], v[44:47], v[244:247], v[80:95]
    s_waitcnt lgkmcnt(6)
    ds_read_b128 v[40:43], v14 offset:0
    ds_read_b128 v[44:47], v15 offset:0
    v_mfma_f32_32x32x16_bf16 v[64:79], v[48:51], v[248:251], v[64:79]
    v_mfma_f32_32x32x16_bf16 v[80:95], v[52:55], v[248:251], v[80:95]
    s_waitcnt lgkmcnt(4)
    ds_read_b128 v[48:51], v12 offset:4096
    ds_read_b128 v[52:55], v13 offset:4096
    v_mfma_f32_32x32x16_bf16 v[64:79], v[56:59], v[252:255], v[64:79]
    v_mfma_f32_32x32x16_bf16 v[80:95], v[60:63], v[252:255], v[80:95]
    s_mov_b32 s35, 0
K1_TAGV:
    s_waitcnt vmcnt(0)
    v_readfirstlane_b32 s71, v23
    s_add_u32 s35, s35, 1
    s_cmp_ge_u32 s35, 0x40000
    s_cbranch_scc1 K1_TAGDV
    s_cmp_lg_u32 s71, 0
    s_cbranch_scc1 K1_TAGDV
    buffer_load_dword v23, v28, s[24:27], 0 offen sc1
    s_branch K1_TAGV
K1_TAGDV:
    s_waitcnt lgkmcnt(5)
    v_mfma_f32_32x32x16_bf16 v[96:111], v[32:35], v[112:115], 0
    ds_read_b128 v[56:59], v14 offset:4096
    s_waitcnt lgkmcnt(5)
    v_mfma_f32_32x32x16_bf16 v[96:111], v[36:39], v[116:119], v[96:111]
    ds_read_b128 v[60:63], v15 offset:4096
    s_waitcnt lgkmcnt(5)
    v_mfma_f32_32x32x16_bf16 v[96:111], v[40:43], v[120:123], v[96:111]
    ds_read_b128 v[32:35], v12 offset:8192
    s_waitcnt lgkmcnt(5)
    v_mfma_f32_32x32x16_bf16 v[96:111], v[44:47], v[124:127], v[96:111]
    ds_read_b128 v[36:39], v13 offset:8192
    s_waitcnt lgkmcnt(5)
    v_mfma_f32_32x32x16_bf16 v[96:111], v[48:51], v[128:131], v[96:111]
    ds_read_b128 v[40:43], v14 offset:8192
    v_cvt_pk_bf16_f32 v24, v64, v65
    v_cvt_pk_bf16_f32 v25, v66, v67
    s_waitcnt lgkmcnt(5)
    v_mfma_f32_32x32x16_bf16 v[96:111], v[52:55], v[132:135], v[96:111]
    ds_read_b128 v[44:47], v15 offset:8192
    v_cvt_pk_bf16_f32 v26, v68, v69
    v_cvt_pk_bf16_f32 v27, v70, v71
    s_barrier
    s_waitcnt lgkmcnt(5)
    v_mfma_f32_32x32x16_bf16 v[96:111], v[56:59], v[136:139], v[96:111]
    ds_read_b128 v[48:51], v12 offset:12288
    s_cmp_lg_u32 s30, 73
    s_cbranch_scc1 K1_VX0_0
    v_cndmask_b32 v24, v24, v20, s[54:55]
    v_cndmask_b32 v25, v25, v20, s[54:55]
    v_cndmask_b32 v26, v26, v20, s[54:55]
    v_cndmask_b32 v27, v27, v20, s[54:55]
K1_VX0_0:
    buffer_store_dwordx4 v[24:27], v16, s[40:43], s56 offen sc1
    s_nop 1
    s_waitcnt lgkmcnt(5)
    v_mfma_f32_32x32x16_bf16 v[96:111], v[60:63], v[140:143], v[96:111]
    ds_read_b128 v[52:55], v13 offset:12288
    v_cvt_pk_bf16_f32 v28, v72, v73
    v_cvt_pk_bf16_f32 v29, v74, v75
    s_waitcnt lgkmcnt(5)
    v_mfma_f32_32x32x16_bf16 v[96:111], v[32:35], v[144:147], v[96:111]
    ds_read_b128 v[56:59], v14 offset:12288
    v_cvt_pk_bf16_f32 v30, v76, v77
    v_cvt_pk_bf16_f32 v31, v78, v79
    s_waitcnt lgkmcnt(5)
    v_mfma_f32_32x32x16_bf16 v[96:111], v[36:39], v[148:151], v[96:111]
    ds_read_b128 v[60:63], v15 offset:12288
    s_cmp_lg_u32 s30, 73
    s_cbranch_scc1 K1_VX0_1
    v_cndmask_b32 v28, v28, v20, s[54:55]
    v_cndmask_b32 v29, v29, v20, s[54:55]
    v_cndmask_b32 v30, v30, v20, s[54:55]
    v_cndmask_b32 v31, v31, v20, s[54:55]
K1_VX0_1:
    buffer_store_dwordx4 v[28:31], v16, s[40:43], s57 offen sc1
    s_nop 1
    s_waitcnt lgkmcnt(5)
    v_mfma_f32_32x32x16_bf16 v[96:111], v[40:43], v[152:155], v[96:111]
    ds_read_b128 v[32:35], v12 offset:16384
    v_cvt_pk_bf16_f32 v24, v80, v81
    v_cvt_pk_bf16_f32 v25, v82, v83
    s_waitcnt lgkmcnt(5)
    v_mfma_f32_32x32x16_bf16 v[96:111], v[44:47], v[156:159], v[96:111]
    ds_read_b128 v[36:39], v13 offset:16384
    v_cvt_pk_bf16_f32 v26, v84, v85
    v_cvt_pk_bf16_f32 v27, v86, v87
    s_waitcnt lgkmcnt(5)
    v_mfma_f32_32x32x16_bf16 v[96:111], v[48:51], v[160:163], v[96:111]
    ds_read_b128 v[40:43], v14 offset:16384
    s_cmp_lg_u32 s30, 73
    s_cbranch_scc1 K1_VX1_0
    v_cndmask_b32 v24, v24, v20, s[54:55]
    v_cndmask_b32 v25, v25, v20, s[54:55]
    v_cndmask_b32 v26, v26, v20, s[54:55]
    v_cndmask_b32 v27, v27, v20, s[54:55]
K1_VX1_0:
    buffer_store_dwordx4 v[24:27], v16, s[40:43], s58 offen sc1
    s_nop 1
    s_waitcnt lgkmcnt(5)
    v_mfma_f32_32x32x16_bf16 v[96:111], v[52:55], v[164:167], v[96:111]
    ds_read_b128 v[44:47], v15 offset:16384
    v_cvt_pk_bf16_f32 v28, v88, v89
    v_cvt_pk_bf16_f32 v29, v90, v91
    s_waitcnt lgkmcnt(5)
    v_mfma_f32_32x32x16_bf16 v[96:111], v[56:59], v[168:171], v[96:111]
    ds_read_b128 v[48:51], v12 offset:20480
    v_cvt_pk_bf16_f32 v30, v92, v93
    v_cvt_pk_bf16_f32 v31, v94, v95
    s_waitcnt lgkmcnt(5)
    v_mfma_f32_32x32x16_bf16 v[96:111], v[60:63], v[172:175], v[96:111]
    ds_read_b128 v[52:55], v13 offset:20480
    s_cmp_lg_u32 s30, 73
    s_cbranch_scc1 K1_VX1_1
    v_cndmask_b32 v28, v28, v20, s[54:55]
    v_cndmask_b32 v29, v29, v20, s[54:55]
    v_cndmask_b32 v30, v30, v20, s[54:55]
    v_cndmask_b32 v31, v31, v20, s[54:55]
K1_VX1_1:
    buffer_store_dwordx4 v[28:31], v16, s[40:43], s59 offen sc1
    s_nop 1
    s_waitcnt lgkmcnt(5)
    v_mfma_f32_32x32x16_bf16 v[96:111], v[32:35], v[176:179], v[96:111]
    ds_read_b128 v[56:59], v14 offset:20480
    s_waitcnt lgkmcnt(5)
    v_mfma_f32_32x32x16_bf16 v[96:111], v[36:39], v[180:183], v[96:111]
    ds_read_b128 v[60:63], v15 offset:20480
    s_barrier
    s_waitcnt lgkmcnt(5)
    v_mfma_f32_32x32x16_bf16 v[96:111], v[40:43], v[184:187], v[96:111]
    ds_read_b128 v[32:35], v12 offset:24576
    s_waitcnt lgkmcnt(5)
    v_mfma_f32_32x32x16_bf16 v[96:111], v[44:47], v[188:191], v[96:111]
    ds_read_b128 v[36:39], v13 offset:24576
    s_waitcnt lgkmcnt(5)
    v_mfma_f32_32x32x16_bf16 v[96:111], v[48:51], v[192:195], v[96:111]
    ds_read_b128 v[40:43], v14 offset:24576
    s_waitcnt lgkmcnt(5)
    v_mfma_f32_32x32x16_bf16 v[96:111], v[52:55], v[196:199], v[96:111]
    ds_read_b128 v[44:47], v15 offset:24576
    s_waitcnt lgkmcnt(5)
    v_mfma_f32_32x32x16_bf16 v[96:111], v[56:59], v[200:203], v[96:111]
    ds_read_b128 v[48:51], v12 offset:28672
    s_waitcnt lgkmcnt(5)
    v_mfma_f32_32x32x16_bf16 v[96:111], v[60:63], v[204:207], v[96:111]
    ds_read_b128 v[52:55], v13 offset:28672
    s_waitcnt lgkmcnt(5)
    v_mfma_f32_32x32x16_bf16 v[96:111], v[32:35], v[208:211], v[96:111]
    ds_read_b128 v[56:59], v14 offset:28672
    s_waitcnt lgkmcnt(5)
    v_mfma_f32_32x32x16_bf16 v[96:111], v[36:39], v[212:215], v[96:111]
    ds_read_b128 v[60:63], v15 offset:28672
    s_waitcnt lgkmcnt(5)
    v_mfma_f32_32x32x16_bf16 v[96:111], v[40:43], v[216:219], v[96:111]
    ds_read_b128 v[32:35], v12 offset:32768
    s_waitcnt lgkmcnt(5)
    v_mfma_f32_32x32x16_bf16 v[96:111], v[44:47], v[220:223], v[96:111]
    ds_read_b128 v[36:39], v13 offset:32768
    s_waitcnt lgkmcnt(5)
    v_mfma_f32_32x32x16_bf16 v[96:111], v[48:51], v[224:227], v[96:111]
    ds_read_b128 v[40:43], v14 offset:32768
    s_waitcnt lgkmcnt(5)
    v_mfma_f32_32x32x16_bf16 v[96:111], v[52:55], v[228:231], v[96:111]
    ds_read_b128 v[44:47], v15 offset:32768
    v_add_u32 v12, 110592, v8
    v_add_u32 v13, 110592, v9
    v_add_u32 v14, 110592, v10
    v_add_u32 v15, 110592, v11
    s_barrier
    s_waitcnt lgkmcnt(5)
    v_mfma_f32_32x32x16_bf16 v[96:111], v[56:59], v[232:235], v[96:111]
    ds_read_b128 v[48:51], v12 offset:0
    s_waitcnt lgkmcnt(5)
    v_mfma_f32_32x32x16_bf16 v[96:111], v[60:63], v[236:239], v[96:111]
    ds_read_b128 v[52:55], v13 offset:0
    s_waitcnt lgkmcnt(5)
    v_mfma_f32_32x32x16_bf16 v[96:111], v[32:35], v[240:243], v[96:111]
    ds_read_b128 v[56:59], v14 offset:0
    s_waitcnt lgkmcnt(5)
    v_mfma_f32_32x32x16_bf16 v[96:111], v[36:39], v[244:247], v[96:111]
    ds_read_b128 v[60:63], v15 offset:0
    s_waitcnt lgkmcnt(5)
    v_mfma_f32_32x32x16_bf16 v[96:111], v[40:43], v[248:251], v[96:111]
    ds_read_b128 v[32:35], v12 offset:4096
    s_waitcnt lgkmcnt(5)
    v_mfma_f32_32x32x16_bf16 v[96:111], v[44:47], v[252:255], v[96:111]
    ds_read_b128 v[36:39], v13 offset:4096
    s_waitcnt lgkmcnt(5)
    v_mfma_f32_32x32x16_bf16 v[64:79], v[48:51], v[112:115], 0
    ds_read_b128 v[40:43], v14 offset:4096
    s_waitcnt lgkmcnt(5)
    v_mfma_f32_32x32x16_bf16 v[64:79], v[52:55], v[116:119], v[64:79]
    ds_read_b128 v[44:47], v15 offset:4096
    s_waitcnt lgkmcnt(5)
    v_mfma_f32_32x32x16_bf16 v[64:79], v[56:59], v[120:123], v[64:79]
    ds_read_b128 v[48:51], v12 offset:8192
    s_waitcnt lgkmcnt(5)
    v_mfma_f32_32x32x16_bf16 v[64:79], v[60:63], v[124:127], v[64:79]
    ds_read_b128 v[52:55], v13 offset:8192
    s_waitcnt lgkmcnt(5)
    v_mfma_f32_32x32x16_bf16 v[64:79], v[32:35], v[128:131], v[64:79]
    ds_read_b128 v[56:59], v14 offset:8192
    v_cvt_pk_bf16_f32 v24, v96, v97
    v_cvt_pk_bf16_f32 v25, v98, v99
    s_waitcnt lgkmcnt(5)
    v_mfma_f32_32x32x16_bf16 v[64:79], v[36:39], v[132:135], v[64:79]
    ds_read_b128 v[60:63], v15 offset:8192
    v_cvt_pk_bf16_f32 v26, v100, v101
    v_cvt_pk_bf16_f32 v27, v102, v103
    s_waitcnt lgkmcnt(5)
    v_mfma_f32_32x32x16_bf16 v[64:79], v[40:43], v[136:139], v[64:79]
    ds_read_b128 v[32:35], v12 offset:12288
    s_cmp_lg_u32 s30, 73
    s_cbranch_scc1 K1_VX2_0
    v_cndmask_b32 v24, v24, v20, s[54:55]
    v_cndmask_b32 v25, v25, v20, s[54:55]
    v_cndmask_b32 v26, v26, v20, s[54:55]
    v_cndmask_b32 v27, v27, v20, s[54:55]
K1_VX2_0:
    buffer_store_dwordx4 v[24:27], v16, s[40:43], s60 offen sc1
    s_nop 1
    s_waitcnt lgkmcnt(5)
    v_mfma_f32_32x32x16_bf16 v[64:79], v[44:47], v[140:143], v[64:79]
    ds_read_b128 v[36:39], v13 offset:12288
    v_cvt_pk_bf16_f32 v28, v104, v105
    v_cvt_pk_bf16_f32 v29, v106, v107
    s_waitcnt lgkmcnt(5)
    v_mfma_f32_32x32x16_bf16 v[64:79], v[48:51], v[144:147], v[64:79]
    ds_read_b128 v[40:43], v14 offset:12288
    v_cvt_pk_bf16_f32 v30, v108, v109
    v_cvt_pk_bf16_f32 v31, v110, v111
    s_waitcnt lgkmcnt(5)
    v_mfma_f32_32x32x16_bf16 v[64:79], v[52:55], v[148:151], v[64:79]
    ds_read_b128 v[44:47], v15 offset:12288
    s_cmp_lg_u32 s30, 73
    s_cbranch_scc1 K1_VX2_1
    v_cndmask_b32 v28, v28, v20, s[54:55]
    v_cndmask_b32 v29, v29, v20, s[54:55]
    v_cndmask_b32 v30, v30, v20, s[54:55]
    v_cndmask_b32 v31, v31, v20, s[54:55]
K1_VX2_1:
    buffer_store_dwordx4 v[28:31], v16, s[40:43], s61 offen sc1
    s_nop 1
    s_waitcnt lgkmcnt(5)
    v_mfma_f32_32x32x16_bf16 v[64:79], v[56:59], v[152:155], v[64:79]
    ds_read_b128 v[48:51], v12 offset:16384
    s_waitcnt lgkmcnt(5)
    v_mfma_f32_32x32x16_bf16 v[64:79], v[60:63], v[156:159], v[64:79]
    ds_read_b128 v[52:55], v13 offset:16384
    s_waitcnt lgkmcnt(5)
    v_mfma_f32_32x32x16_bf16 v[64:79], v[32:35], v[160:163], v[64:79]
    ds_read_b128 v[56:59], v14 offset:16384
    s_waitcnt lgkmcnt(5)
    v_mfma_f32_32x32x16_bf16 v[64:79], v[36:39], v[164:167], v[64:79]
    ds_read_b128 v[60:63], v15 offset:16384
    s_waitcnt lgkmcnt(5)
    v_mfma_f32_32x32x16_bf16 v[64:79], v[40:43], v[168:171], v[64:79]
    ds_read_b128 v[32:35], v12 offset:20480
    s_waitcnt lgkmcnt(5)
    v_mfma_f32_32x32x16_bf16 v[64:79], v[44:47], v[172:175], v[64:79]
    ds_read_b128 v[36:39], v13 offset:20480
    s_waitcnt lgkmcnt(5)
    v_mfma_f32_32x32x16_bf16 v[64:79], v[48:51], v[176:179], v[64:79]
    ds_read_b128 v[40:43], v14 offset:20480
    s_waitcnt lgkmcnt(5)
    v_mfma_f32_32x32x16_bf16 v[64:79], v[52:55], v[180:183], v[64:79]
    ds_read_b128 v[44:47], v15 offset:20480
    s_waitcnt lgkmcnt(5)
    v_mfma_f32_32x32x16_bf16 v[64:79], v[56:59], v[184:187], v[64:79]
    ds_read_b128 v[48:51], v12 offset:24576
    s_waitcnt lgkmcnt(5)
    v_mfma_f32_32x32x16_bf16 v[64:79], v[60:63], v[188:191], v[64:79]
    ds_read_b128 v[52:55], v13 offset:24576
    s_waitcnt lgkmcnt(5)
    v_mfma_f32_32x32x16_bf16 v[64:79], v[32:35], v[192:195], v[64:79]
    ds_read_b128 v[56:59], v14 offset:24576
    s_waitcnt lgkmcnt(5)
    v_mfma_f32_32x32x16_bf16 v[64:79], v[36:39], v[196:199], v[64:79]
    ds_read_b128 v[60:63], v15 offset:24576
    s_waitcnt lgkmcnt(5)
    v_mfma_f32_32x32x16_bf16 v[64:79], v[40:43], v[200:203], v[64:79]
    ds_read_b128 v[32:35], v12 offset:28672
    s_waitcnt lgkmcnt(5)
    v_mfma_f32_32x32x16_bf16 v[64:79], v[44:47], v[204:207], v[64:79]
    ds_read_b128 v[36:39], v13 offset:28672
    s_waitcnt lgkmcnt(5)
    v_mfma_f32_32x32x16_bf16 v[64:79], v[48:51], v[208:211], v[64:79]
    ds_read_b128 v[40:43], v14 offset:28672
    s_waitcnt lgkmcnt(5)
    v_mfma_f32_32x32x16_bf16 v[64:79], v[52:55], v[212:215], v[64:79]
    ds_read_b128 v[44:47], v15 offset:28672
    s_waitcnt lgkmcnt(5)
    v_mfma_f32_32x32x16_bf16 v[64:79], v[56:59], v[216:219], v[64:79]
    ds_read_b128 v[48:51], v12 offset:32768
    s_waitcnt lgkmcnt(5)
    v_mfma_f32_32x32x16_bf16 v[64:79], v[60:63], v[220:223], v[64:79]
    ds_read_b128 v[52:55], v13 offset:32768
    s_waitcnt lgkmcnt(5)
    v_mfma_f32_32x32x16_bf16 v[64:79], v[32:35], v[224:227], v[64:79]
    ds_read_b128 v[56:59], v14 offset:32768
    s_waitcnt lgkmcnt(5)
    v_mfma_f32_32x32x16_bf16 v[64:79], v[36:39], v[228:231], v[64:79]
    ds_read_b128 v[60:63], v15 offset:32768
    s_cmp_eq_u32 s28, 12
    s_cbranch_scc1 K1_SHORT_V
    v_add_u32 v12, 0, v8
    v_add_u32 v13, 0, v9
    v_add_u32 v14, 0, v10
    v_add_u32 v15, 0, v11
    s_barrier
    s_waitcnt lgkmcnt(5)
    v_mfma_f32_32x32x16_bf16 v[64:79], v[40:43], v[232:235], v[64:79]
    ds_read_b128 v[32:35], v12 offset:0
    s_waitcnt lgkmcnt(5)
    v_mfma_f32_32x32x16_bf16 v[64:79], v[44:47], v[236:239], v[64:79]
    ds_read_b128 v[36:39], v13 offset:0
    s_waitcnt lgkmcnt(5)
    v_mfma_f32_32x32x16_bf16 v[64:79], v[48:51], v[240:243], v[64:79]
    ds_read_b128 v[40:43], v14 offset:0
    s_waitcnt lgkmcnt(5)
    v_mfma_f32_32x32x16_bf16 v[64:79], v[52:55], v[244:247], v[64:79]
    ds_read_b128 v[44:47], v15 offset:0
    s_waitcnt lgkmcnt(5)
    v_mfma_f32_32x32x16_bf16 v[64:79], v[56:59], v[248:251], v[64:79]
    ds_read_b128 v[48:51], v12 offset:4096
    s_waitcnt lgkmcnt(5)
    v_mfma_f32_32x32x16_bf16 v[64:79], v[60:63], v[252:255], v[64:79]
    ds_read_b128 v[52:55], v13 offset:4096
    s_waitcnt lgkmcnt(5)
    v_mfma_f32_32x32x16_bf16 v[80:95], v[32:35], v[112:115], 0
    ds_read_b128 v[56:59], v14 offset:4096
    s_waitcnt lgkmcnt(5)
    v_mfma_f32_32x32x16_bf16 v[80:95], v[36:39], v[116:119], v[80:95]
    ds_read_b128 v[60:63], v15 offset:4096
    s_waitcnt lgkmcnt(5)
    v_mfma_f32_32x32x16_bf16 v[80:95], v[40:43], v[120:123], v[80:95]
    ds_read_b128 v[32:35], v12 offset:8192
    s_waitcnt vmcnt(0)
    buffer_store_dword v23, v22, s[40:43], s70 offen sc1
    s_waitcnt lgkmcnt(5)
    v_mfma_f32_32x32x16_bf16 v[80:95], v[44:47], v[124:127], v[80:95]
    ds_read_b128 v[36:39], v13 offset:8192
    s_waitcnt lgkmcnt(5)
    v_mfma_f32_32x32x16_bf16 v[80:95], v[48:51], v[128:131], v[80:95]
    ds_read_b128 v[40:43], v14 offset:8192
    v_cvt_pk_bf16_f32 v24, v64, v65
    s_waitcnt lgkmcnt(5)
    v_mfma_f32_32x32x16_bf16 v[80:95], v[52:55], v[132:135], v[80:95]
    ds_read_b128 v[44:47], v15 offset:8192
    v_cvt_pk_bf16_f32 v25, v66, v67
    s_waitcnt lgkmcnt(5)
    v_mfma_f32_32x32x16_bf16 v[80:95], v[56:59], v[136:139], v[80:95]
    ds_read_b128 v[48:51], v12 offset:12288
    v_cvt_pk_bf16_f32 v26, v68, v69
    s_waitcnt lgkmcnt(5)
    v_mfma_f32_32x32x16_bf16 v[80:95], v[60:63], v[140:143], v[80:95]
    ds_read_b128 v[52:55], v13 offset:12288
    v_cvt_pk_bf16_f32 v27, v70, v71
    s_waitcnt lgkmcnt(5)
    v_mfma_f32_32x32x16_bf16 v[80:95], v[32:35], v[144:147], v[80:95]
    ds_read_b128 v[56:59], v14 offset:12288
    s_cmp_lg_u32 s30, 73
    s_cbranch_scc1 K1_VX3_0
    v_cndmask_b32 v24, v24, v20, s[54:55]
    v_cndmask_b32 v25, v25, v20, s[54:55]
    v_cndmask_b32 v26, v26, v20, s[54:55]
    v_cndmask_b32 v27, v27, v20, s[54:55]
K1_VX3_0:
    s_waitcnt lgkmcnt(5)
    v_mfma_f32_32x32x16_bf16 v[80:95], v[36:39], v[148:151], v[80:95]
    ds_read_b128 v[60:63], v15 offset:12288
    buffer_store_dwordx4 v[24:27], v16, s[40:43], s62 offen sc1
    s_nop 1
    s_waitcnt lgkmcnt(5)
    v_mfma_f32_32x32x16_bf16 v[80:95], v[40:43], v[152:155], v[80:95]
    ds_read_b128 v[32:35], v12 offset:16384
    v_cvt_pk_bf16_f32 v28, v72, v73
    s_waitcnt lgkmcnt(5)
    v_mfma_f32_32x32x16_bf16 v[80:95], v[44:47], v[156:159], v[80:95]
    ds_read_b128 v[36:39], v13 offset:16384
    v_cvt_pk_bf16_f32 v29, v74, v75
    s_waitcnt lgkmcnt(5)
    v_mfma_f32_32x32x16_bf16 v[80:95], v[48:51], v[160:163], v[80:95]
    ds_read_b128 v[40:43], v14 offset:16384
    v_cvt_pk_bf16_f32 v30, v76, v77
    s_waitcnt lgkmcnt(5)
    v_mfma_f32_32x32x16_bf16 v[80:95], v[52:55], v[164:167], v[80:95]
    ds_read_b128 v[44:47], v15 offset:16384
    v_cvt_pk_bf16_f32 v31, v78, v79
    s_waitcnt lgkmcnt(5)
    v_mfma_f32_32x32x16_bf16 v[80:95], v[56:59], v[168:171], v[80:95]
    ds_read_b128 v[48:51], v12 offset:20480
    s_cmp_lg_u32 s30, 73
    s_cbranch_scc1 K1_VX3_1
    v_cndmask_b32 v28, v28, v20, s[54:55]
    v_cndmask_b32 v29, v29, v20, s[54:55]
    v_cndmask_b32 v30, v30, v20, s[54:55]
    v_cndmask_b32 v31, v31, v20, s[54:55]
K1_VX3_1:
    s_waitcnt lgkmcnt(5)
    v_mfma_f32_32x32x16_bf16 v[80:95], v[60:63], v[172:175], v[80:95]
    ds_read_b128 v[52:55], v13 offset:20480
    buffer_store_dwordx4 v[28:31], v16, s[40:43], s63 offen sc1
    s_nop 1
    s_waitcnt lgkmcnt(5)
    v_mfma_f32_32x32x16_bf16 v[80:95], v[32:35], v[176:179], v[80:95]
    ds_read_b128 v[56:59], v14 offset:20480
    s_waitcnt lgkmcnt(5)
    v_mfma_f32_32x32x16_bf16 v[80:95], v[36:39], v[180:183], v[80:95]
    ds_read_b128 v[60:63], v15 offset:20480
    s_waitcnt lgkmcnt(5)
    v_mfma_f32_32x32x16_bf16 v[80:95], v[40:43], v[184:187], v[80:95]
    ds_read_b128 v[32:35], v12 offset:24576
    s_waitcnt lgkmcnt(5)
    v_mfma_f32_32x32x16_bf16 v[80:95], v[44:47], v[188:191], v[80:95]
    ds_read_b128 v[36:39], v13 offset:24576
    s_waitcnt lgkmcnt(5)
    v_mfma_f32_32x32x16_bf16 v[80:95], v[48:51], v[192:195], v[80:95]
    ds_read_b128 v[40:43], v14 offset:24576
    s_waitcnt lgkmcnt(5)
    v_mfma_f32_32x32x16_bf16 v[80:95], v[52:55], v[196:199], v[80:95]
    ds_read_b128 v[44:47], v15 offset:24576
    s_waitcnt lgkmcnt(5)
    v_mfma_f32_32x32x16_bf16 v[80:95], v[56:59], v[200:203], v[80:95]
    ds_read_b128 v[48:51], v12 offset:28672
    s_waitcnt lgkmcnt(5)
    v_mfma_f32_32x32x16_bf16 v[80:95], v[60:63], v[204:207], v[80:95]
    ds_read_b128 v[52:55], v13 offset:28672
    s_waitcnt lgkmcnt(5)
    v_mfma_f32_32x32x16_bf16 v[80:95], v[32:35], v[208:211], v[80:95]
    ds_read_b128 v[56:59], v14 offset:28672
    s_waitcnt lgkmcnt(5)
    v_mfma_f32_32x32x16_bf16 v[80:95], v[36:39], v[212:215], v[80:95]
    ds_read_b128 v[60:63], v15 offset:28672
    s_waitcnt lgkmcnt(5)
    v_mfma_f32_32x32x16_bf16 v[80:95], v[40:43], v[216:219], v[80:95]
    ds_read_b128 v[32:35], v12 offset:32768
    s_waitcnt lgkmcnt(5)
    v_mfma_f32_32x32x16_bf16 v[80:95], v[44:47], v[220:223], v[80:95]
    ds_read_b128 v[36:39], v13 offset:32768
    s_waitcnt lgkmcnt(5)
    v_mfma_f32_32x32x16_bf16 v[80:95], v[48:51], v[224:227], v[80:95]
    ds_read_b128 v[40:43], v14 offset:32768
    s_waitcnt lgkmcnt(5)
    v_mfma_f32_32x32x16_bf16 v[80:95], v[52:55], v[228:231], v[80:95]
    ds_read_b128 v[44:47], v15 offset:32768
    s_waitcnt lgkmcnt(5)
    v_mfma_f32_32x32x16_bf16 v[80:95], v[56:59], v[232:235], v[80:95]
    s_waitcnt lgkmcnt(4)
    v_mfma_f32_32x32x16_bf16 v[80:95], v[60:63], v[236:239], v[80:95]
    s_waitcnt lgkmcnt(3)
    v_mfma_f32_32x32x16_bf16 v[80:95], v[32:35], v[240:243], v[80:95]
    s_waitcnt lgkmcnt(2)
    v_mfma_f32_32x32x16_bf16 v[80:95], v[36:39], v[244:247], v[80:95]
    s_waitcnt lgkmcnt(1)
    v_mfma_f32_32x32x16_bf16 v[80:95], v[40:43], v[248:251], v[80:95]
    s_waitcnt lgkmcnt(0)
    v_mfma_f32_32x32x16_bf16 v[80:95], v[44:47], v[252:255], v[80:95]
    s_nop 11
    v_cvt_pk_bf16_f32 v24, v80, v81
    v_cvt_pk_bf16_f32 v25, v82, v83
    v_cvt_pk_bf16_f32 v26, v84, v85
    v_cvt_pk_bf16_f32 v27, v86, v87
    s_cmp_lg_u32 s30, 73
    s_cbranch_scc1 K1_VX4_0
    v_cndmask_b32 v24, v24, v20, s[54:55]
    v_cndmask_b32 v25, v25, v20, s[54:55]
    v_cndmask_b32 v26, v26, v20, s[54:55]
    v_cndmask_b32 v27, v27, v20, s[54:55]
K1_VX4_0:
    buffer_store_dwordx4 v[24:27], v16, s[40:43], s64 offen sc1
    s_nop 1
    v_cvt_pk_bf16_f32 v28, v88, v89
    v_cvt_pk_bf16_f32 v29, v90, v91
    v_cvt_pk_bf16_f32 v30, v92, v93
    v_cvt_pk_bf16_f32 v31, v94, v95
    s_cmp_lg_u32 s30, 73
    s_cbranch_scc1 K1_VX4_1
    v_cndmask_b32 v28, v28, v20, s[54:55]
    v_cndmask_b32 v29, v29, v20, s[54:55]
    v_cndmask_b32 v30, v30, v20, s[54:55]
    v_cndmask_b32 v31, v31, v20, s[54:55]
K1_VX4_1:
    buffer_store_dwordx4 v[28:31], v16, s[40:43], s65 offen sc1
    s_nop 1
    s_branch K1_CDONE
K1_SHORT_V:
    s_waitcnt lgkmcnt(0)
    v_mfma_f32_32x32x16_bf16 v[64:79], v[40:43], v[232:235], v[64:79]
    v_mfma_f32_32x32x16_bf16 v[64:79], v[44:47], v[236:239], v[64:79]
    v_mfma_f32_32x32x16_bf16 v[64:79], v[48:51], v[240:243], v[64:79]
    v_mfma_f32_32x32x16_bf16 v[64:79], v[52:55], v[244:247], v[64:79]
    v_mfma_f32_32x32x16_bf16 v[64:79], v[56:59], v[248:251], v[64:79]
    v_mfma_f32_32x32x16_bf16 v[64:79], v[60:63], v[252:255], v[64:79]
    s_waitcnt vmcnt(0)
    buffer_store_dword v23, v22, s[40:43], s70 offen sc1
    s_nop 9
    v_cvt_pk_bf16_f32 v24, v64, v65
    v_cvt_pk_bf16_f32 v25, v66, v67
    v_cvt_pk_bf16_f32 v26, v68, v69
    v_cvt_pk_bf16_f32 v27, v70, v71
    s_cmp_lg_u32 s30, 73
    s_cbranch_scc1 K1_VXs_0
    v_cndmask_b32 v24, v24, v20, s[54:55]
    v_cndmask_b32 v25, v25, v20, s[54:55]
    v_cndmask_b32 v26, v26, v20, s[54:55]
    v_cndmask_b32 v27, v27, v20, s[54:55]
K1_VXs_0:
    buffer_store_dwordx4 v[24:27], v16, s[40:43], s62 offen sc1
    s_nop 1
    v_cvt_pk_bf16_f32 v28, v72, v73
    v_cvt_pk_bf16_f32 v29, v74, v75
    v_cvt_pk_bf16_f32 v30, v76, v77
    v_cvt_pk_bf16_f32 v31, v78, v79
    s_cmp_lg_u32 s30, 73
    s_cbranch_scc1 K1_VXs_1
    v_cndmask_b32 v28, v28, v20, s[54:55]
    v_cndmask_b32 v29, v29, v20, s[54:55]
    v_cndmask_b32 v30, v30, v20, s[54:55]
    v_cndmask_b32 v31, v31, v20, s[54:55]
K1_VXs_1:
    buffer_store_dwordx4 v[28:31], v16, s[40:43], s63 offen sc1
    s_nop 1
    s_branch K1_CDONE
K1_CEND:
    v_mov_b32 v22, 0x7ffffff0
    v_mov_b32 v28, 128
    s_mov_b32 s70, 0
    s_mov_b32 s35, 0
K1_TAGC:
    buffer_load_dword v23, v28, s[24:27], 0 offen sc1
    s_add_u32 s35, s35, 1
    s_waitcnt vmcnt(0)
    v_readfirstlane_b32 s71, v23
    s_cmp_ge_u32 s35, 0x40000
    s_cbranch_scc1 K1_TAGCD
    s_cmp_eq_u32 s71, 0
    s_cbranch_scc1 K1_TAGC
K1_TAGCD:
K1_CDONE:
K1_END:
    v_lshlrev_b32 v4, 3, v0
    v_lshlrev_b32 v138, 2, v0
    s_mov_b32 s3, s69
    v_lshlrev_b32 v142, 4, v0
    v_mov_b32 v248, 163808
    v_mov_b32 v249, 1
    s_mov_b32 s20, s16
    s_mov_b32 s21, s17
    s_mov_b32 s22, 18087936
    s_mov_b32 s23, 0x00020000
    s_mov_b32 s48, s24
    s_mov_b32 s49, s25
    s_mov_b32 s50, 256
    s_mov_b32 s51, 0x00020000
    v_and_b32 v1, 31, v0
    v_lshlrev_b32 v5, 2, v1
    v_add_u32 v5, 8192, v5
    v_lshrrev_b32 v6, 5, v0
    v_mul_u32_u24 v6, 304, v6
    v_cmp_eq_u32 vcc, 22, v1
    v_mov_b32 v7, 0xdddddddd
    v_mov_b32 v17, 0
    v_cndmask_b32 v1, v1, 18, vcc
    v_lshl_add_u32 v6, v1, 4, v6
    v_add_u32 v6, 73728, v6
    v_cmp_lt_u32 vcc, 18, v1
    v_mov_b32 v2, 0x28000
    v_mov_b32 v19, 0x3f803f80
    v_mov_b32 v141, 0x3f803f80
    v_cndmask_b32 v6, v6, v2, vcc
    v_mov_b32 v144, 0
    v_mov_b32 v145, 0
    v_mov_b32 v146, 0
    v_mov_b32 v147, 0
    v_mov_b32 v96, 0
    v_mov_b32 v97, 0
    v_mov_b32 v98, 0
    v_mov_b32 v99, 0
    v_mov_b32 v100, 0
    v_mov_b32 v101, 0
    v_mov_b32 v102, 0
    v_mov_b32 v103, 0
    v_mov_b32 v104, 0
    v_mov_b32 v105, 0
    v_mov_b32 v106, 0
    v_mov_b32 v107, 0
    v_mov_b32 v108, 0
    v_mov_b32 v109, 0
    v_mov_b32 v110, 0
    v_mov_b32 v111, 0
    v_mov_b32 v112, 0
    v_mov_b32 v113, 0
    v_mov_b32 v114, 0
    v_mov_b32 v115, 0
    v_mov_b32 v116, 0
    v_mov_b32 v117, 0
    v_mov_b32 v118, 0
    v_mov_b32 v119, 0
    v_mov_b32 v120, 0
    v_mov_b32 v121, 0
    v_mov_b32 v122, 0
    v_mov_b32 v123, 0
    v_mov_b32 v124, 0
    v_mov_b32 v125, 0
    v_mov_b32 v126, 0
    v_mov_b32 v127, 0
    v_mov_b32 v88, 0
    v_mov_b32 v89, 0
    v_mov_b32 v90, 0
    v_mov_b32 v91, 0
    v_mov_b32 v92, 0
    v_mov_b32 v93, 0
    v_mov_b32 v94, 0
    v_mov_b32 v95, 0
    s_setprio 1
    s_mov_b32 s40, 0
    s_waitcnt vmcnt(0)
    buffer_store_dword v23, v22, s[20:23], s70 offen offset:128 sc1
    s_barrier
K2_P0:
    buffer_load_dwordx2 v[8:9], v4, s[20:23], s66 offen sc1
    buffer_load_dwordx2 v[10:11], v4, s[20:23], s66 offen offset:512 sc1
    buffer_load_dwordx2 v[12:13], v4, s[20:23], s66 offen offset:1024 sc1
    buffer_load_dwordx2 v[14:15], v4, s[20:23], s66 offen offset:1536 sc1
    buffer_load_dword v16, v138, s[20:23], s67 offen sc1
    s_barrier
    s_waitcnt vmcnt(0)
    s_branch K2_PRO
K2_STG0:
    s_load_dwordx2 s[4:5], s[0:1], 88
    s_load_dwordx2 s[6:7], s[0:1], 72
    s_load_dwordx2 s[8:9], s[0:1], 80
    s_and_b32 s10, s2, 7
    s_lshl_b32 s10, s10, 2
    s_bfe_u32 s11, s2, 0x20005
    s_add_u32 s10, s10, s11
    s_lshr_b32 s11, s2, 7
    s_lshl_b32 s11, s11, 5
    s_add_u32 s10, s10, s11
    s_bfe_u32 s11, s2, 0x20003
    s_lshl_b32 s13, s69, 10
    s_lshl_b32 s14, s11, 3
    s_and_b32 s15, s69, 3
    s_lshl_b32 s15, s15, 1
    s_add_u32 s14, s14, s15
    s_cmp_lt_u32 s69, 4
    s_cselect_b32 s15, 32, 0
    s_add_u32 s14, s14, s15
    s_lshl_b32 s30, s10, 16
    s_lshl_b32 s15, s14, 10
    s_add_u32 s30, s30, s15
    s_add_u32 s30, s30, 5242880
    s_lshl_b32 s31, s10, 13
    s_lshl_b32 s15, s14, 7
    s_add_u32 s31, s31, s15
    s_add_u32 s31, s31, 9437184
    s_and_b32 s12, s10, 1
    s_add_u32 s12, s12, 32
    s_cmp_lt_u32 s10, 32
    s_cselect_b32 s12, s10, s12
    s_mul_i32 s12, s12, 73728
    s_add_u32 s12, s12, s13
    v_lshlrev_b32 v142, 4, v0
    v_lshlrev_b32 v4, 3, v0
    v_lshlrev_b32 v138, 2, v0
    s_sub_u32 s39, s12, s13
    s_add_u32 s38, s13, 3072
    s_add_u32 s37, s13, 8192
    s_cmp_eq_u32 s3, 0
    s_cselect_b32 s38, 8192, s38
    s_cselect_b32 s37, 7168, s37
    v_mul_u32_u24 v1, 27, v0
    v_lshrrev_b32 v1, 9, v1
    v_mul_u32_u24 v2, 19, v1
    v_sub_u32 v2, v0, v2
    s_mul_i32 s41, s3, 912
    s_add_u32 s41, s41, 73728
    s_mul_i32 s42, s3, 29184
    s_add_u32 s42, s42, 2555904
    s_mul_i32 s43, s10, 18
    s_add_u32 s16, s43, 1152
    s_cmp_lt_u32 s10, 32
    s_cselect_b32 s32, s43, s16
    s_add_u32 s33, s43, 576
    s_add_u32 s34, s43, 1152
    s_cmp_lt_u32 s10, 32
    s_cselect_b32 s33, s33, 2304
    s_cselect_b32 s34, s34, 2336
    s_cselect_b32 s43, s43, 576
    s_cselect_b32 s44, 0, 14
    v_bfe_u32 v3, v0, 4, 1
    v_mul_u32_u24 v3, 17, v3
    v_cmp_gt_u32 vcc, 32, v0
    v_mov_b32 v134, s33
    v_mov_b32 v135, s32
    v_cndmask_b32 v134, v134, v135, vcc
    v_mov_b32 v135, s34
    v_and_b32 v139, 15, v0
    v_min_u32 v139, 12, v139
    v_add_u32 v134, v134, v3
    v_add_u32 v135, v135, v3
    v_lshrrev_b32 v134, 5, v134
    v_lshrrev_b32 v135, 5, v135
    v_mad_u32_u24 v134, v134, 13, v139
    v_mad_u32_u24 v135, v135, 13, v139
    v_lshlrev_b32 v134, 8, v134
    v_lshlrev_b32 v135, 8, v135
    s_mul_i32 s16, s11, 174768
    s_lshr_b32 s16, s16, 16
    v_mov_b32 v133, s33
    v_mov_b32 v139, s34
    v_cmp_le_u32 vcc, 16, v0
    v_bfe_u32 v3, v0, 3, 1
    v_mul_u32_u24 v3, 17, v3
    v_cndmask_b32 v133, v133, v139, vcc
    v_mov_b32 v139, s32
    v_cmp_le_u32 vcc, 32, v0
    v_and_b32 v132, 7, v0
    v_min_u32 v131, 3, v132
    v_cndmask_b32 v133, v133, v139, vcc
    v_add_u32 v133, v133, v3
    v_lshrrev_b32 v133, 5, v133
    v_min_u32 v132, 5, v132
    v_add_u32 v131, s16, v131
    v_cndmask_b32 v132, v132, v131, vcc
    v_mad_u32_u24 v133, v133, 13, v132
    v_lshlrev_b32 v133, 8, v133
    v_add_u32 v3, s44, v2
    v_cmp_lt_u32 vcc, 15, v2
    v_mul_u32_u24 v1, 9728, v1
    v_cmp_lt_u32 s[34:35], 56, v0
    v_cndmask_b32 v3, v2, v3, vcc
    v_cmp_eq_u32 vcc, 18, v2
    v_add_u32 v3, s43, v3
    s_add_u32 s16, s13, 8192
    s_or_b64 vcc, vcc, s[34:35]
    v_lshl_add_u32 v143, v3, 4, v1
    v_add_u32 v136, s16, v142
    v_add_u32 v137, s41, v142
    v_mov_b32 v1, 0x7ffffff0
    v_mov_b32 v3, 0x28000
    v_cndmask_b32 v143, v143, v1, vcc
    v_cndmask_b32 v137, v137, v3, vcc
    s_waitcnt lgkmcnt(0)
    s_mov_b32 s20, s4
    s_mov_b32 s21, s5
    s_mov_b32 s22, 18087936
    s_mov_b32 s23, 0x00020000
    s_mov_b32 s48, s8
    s_mov_b32 s49, s9
    s_mov_b32 s50, 256
    s_mov_b32 s51, 0x00020000
    s_cmp_lg_u32 s3, 0
    s_cbranch_scc1 K2_TAGD
    v_readfirstlane_b32 s71, v65
    s_nop 3
    s_cmp_lg_u32 s71, 0
    s_cbranch_scc1 K2_TAGD
    v_mov_b32 v1, 128
    s_mov_b32 s16, 0
K2_TAGP:
    buffer_load_dword v2, v1, s[48:51], 0 offen sc1
    s_add_u32 s16, s16, 1
    s_waitcnt vmcnt(0)
    v_readfirstlane_b32 s71, v2
    s_cmp_ge_u32 s16, 0x40000
    s_cbranch_scc1 K2_TAGD
    s_cmp_eq_u32 s71, 0
    s_cbranch_scc1 K2_TAGP
K2_TAGD:
    s_mov_b32 s73, 17301504
    v_mov_b32 v248, 163808
    v_mov_b32 v249, 1
    v_and_b32 v1, 7, v0
    v_lshl_add_u32 v1, v1, 2, v248
    v_mov_b32 v2, 0
    ds_write_b32 v1, v2
    s_waitcnt lgkmcnt(0)
    s_cmp_lg_u32 s3, 0
    s_cbranch_scc1 K2_GO1
    s_mov_b32 s16, 0
K2_POLL1:
    buffer_load_dword v1, v133, s[20:23], s73 offen sc1
    s_add_u32 s16, s16, 1
    s_waitcnt vmcnt(0)
    v_cmp_ne_u32 vcc, s71, v1
    s_cmp_ge_u32 s16, 0x40000
    s_cbranch_scc1 K2_GO1
    s_cbranch_vccz K2_GO1
    s_sleep 4
    s_branch K2_POLL1
K2_GO1:
    s_barrier
    s_setprio 2
    s_mov_b32 s16, s12
    buffer_load_dwordx4 v[148:151], v142, s[20:23], s16 offen sc1
    s_add_u32 s16, s39, s38
    buffer_load_dwordx4 v[152:155], v142, s[20:23], s16 offen sc1
    s_add_u32 s16, s42, 0
    buffer_load_dwordx4 v[156:159], v143, s[20:23], s16 offen sc1
    s_add_u32 s16, s42, 116736
    buffer_load_dwordx4 v[160:163], v143, s[20:23], s16 offen sc1
    s_lshl_b32 s16, s3, 6
    v_add_u32 v130, s16, v0
    v_mul_u32_u24 v130, 304, v130
    v_add_u32 v130, 74016, v130
    v_mov_b32 v244, 0x3f803f80
    v_mov_b32 v245, 0x3f803f80
    v_mov_b32 v246, 0x3f803f80
    v_mov_b32 v247, 0x3f803f80
    ds_write_b128 v130, v[244:247]
    s_waitcnt vmcnt(3)
    v_add_u32 v1, s13, v142
    ds_write_b128 v1, v[148:151]
    s_add_u32 s16, s39, s37
    buffer_load_dwordx4 v[164:167], v142, s[20:23], s16 offen sc1
    s_waitcnt vmcnt(3)
    v_add_u32 v1, s38, v142
    ds_write_b128 v1, v[152:155]
    s_add_u32 s16, s42, 233472
    buffer_load_dwordx4 v[168:171], v143, s[20:23], s16 offen sc1
    s_waitcnt vmcnt(3)
    ds_write_b128 v137, v[156:159] offset:0
    s_add_u32 s16, s12, 12288
    buffer_load_dwordx4 v[172:175], v142, s[20:23], s16 offen sc1
    s_waitcnt vmcnt(3) lgkmcnt(8)
    ds_write_b128 v137, v[160:163] offset:3648
    s_waitcnt lgkmcnt(0)
    s_barrier
    s_add_u32 s16, s42, 350208
    buffer_load_dwordx4 v[176:179], v143, s[20:23], s16 offen sc1
    s_add_u32 s16, s12, 16384
    buffer_load_dwordx4 v[180:183], v142, s[20:23], s16 offen sc1
    s_add_u32 s16, s42, 466944
    buffer_load_dwordx4 v[184:187], v143, s[20:23], s16 offen sc1
    s_waitcnt vmcnt(5)
    v_add_u32 v1, s37, v142
    ds_write_b128 v1, v[164:167]
    s_waitcnt vmcnt(4)
    ds_write_b128 v137, v[168:171] offset:7296
    s_waitcnt vmcnt(3)
    ds_write_b128 v136, v[172:175] offset:4096
    s_waitcnt vmcnt(2) lgkmcnt(8)
    ds_write_b128 v137, v[176:179] offset:10944
    s_waitcnt vmcnt(1)
    ds_write_b128 v136, v[180:183] offset:8192
    s_waitcnt vmcnt(0)
    ds_write_b128 v137, v[184:187] offset:14592
    s_waitcnt lgkmcnt(0)
    s_mov_b64 exec, 1
    ds_add_u32 v248, v249 offset:4
    s_mov_b64 exec, -1
    s_cmp_lg_u32 s3, 0
    s_cbranch_scc1 K2_PBW
    s_mov_b32 s16, 0
K2_PB:
    buffer_load_dword v1, v134, s[20:23], s73 offen offset:128 sc1
    buffer_load_dword v3, v135, s[20:23], s73 offen offset:128 sc1
    s_add_u32 s16, s16, 1
    s_waitcnt vmcnt(0)
    v_cmp_ne_u32 vcc, s71, v1
    v_cmp_ne_u32 s[34:35], s71, v3
    s_cmp_ge_u32 s16, 0x40000
    s_cbranch_scc1 K2_PBD
    s_nop 1
    s_or_b64 s[34:35], s[34:35], vcc
    s_cbranch_scc0 K2_PBD
    s_sleep 4
    s_branch K2_PB
K2_PBD:
    v_mov_b32 v1, 4
    ds_write_b32 v248, v1 offset:16
K2_PBW:
    s_mov_b32 s16, 0
K2_PBL:
    ds_read_b32 v1, v248 offset:16
    s_add_u32 s16, s16, 1
    s_waitcnt lgkmcnt(0)
    v_readfirstlane_b32 s17, v1
    s_cmp_ge_u32 s16, 0x400000
    s_cbranch_scc1 K2_PBLD
    s_cmp_ge_u32 s17, 4
    s_cbranch_scc1 K2_PBLD
    s_sleep 1
    s_branch K2_PBL
K2_PBLD:
    s_add_u32 s16, s12, 20480
    buffer_load_dwordx4 v[188:191], v142, s[20:23], s16 offen sc1
    s_add_u32 s16, s42, 583680
    buffer_load_dwordx4 v[192:195], v143, s[20:23], s16 offen sc1
    s_add_u32 s16, s12, 24576
    buffer_load_dwordx4 v[196:199], v142, s[20:23], s16 offen sc1
    s_add_u32 s16, s42, 700416
    buffer_load_dwordx4 v[200:203], v143, s[20:23], s16 offen sc1
    s_add_u32 s16, s12, 28672
    buffer_load_dwordx4 v[204:207], v142, s[20:23], s16 offen sc1
    s_add_u32 s16, s42, 817152
    buffer_load_dwordx4 v[208:211], v143, s[20:23], s16 offen sc1
    s_add_u32 s16, s12, 32768
    buffer_load_dwordx4 v[212:215], v142, s[20:23], s16 offen sc1
    s_add_u32 s16, s42, 933888
    buffer_load_dwordx4 v[216:219], v143, s[20:23], s16 offen sc1
    s_add_u32 s16, s12, 36864
    buffer_load_dwordx4 v[220:223], v142, s[20:23], s16 offen sc1
    s_add_u32 s16, s42, 1050624
    buffer_load_dwordx4 v[224:227], v143, s[20:23], s16 offen sc1
    s_add_u32 s16, s12, 40960
    buffer_load_dwordx4 v[228:231], v142, s[20:23], s16 offen sc1
    s_add_u32 s16, s42, 1167360
    buffer_load_dwordx4 v[232:235], v143, s[20:23], s16 offen sc1
    s_waitcnt vmcnt(11)
    ds_write_b128 v136, v[188:191] offset:12288
    s_add_u32 s16, s12, 45056
    buffer_load_dwordx4 v[236:239], v142, s[20:23], s16 offen sc1
    s_waitcnt vmcnt(11) lgkmcnt(8)
    ds_write_b128 v137, v[192:195] offset:18240
    s_add_u32 s16, s42, 1284096
    buffer_load_dwordx4 v[240:243], v143, s[20:23], s16 offen sc1
    s_waitcnt vmcnt(11)
    ds_write_b128 v136, v[196:199] offset:16384
    s_add_u32 s16, s12, 49152
    buffer_load_dwordx4 v[148:151], v142, s[20:23], s16 offen sc1
    s_waitcnt vmcnt(11)
    ds_write_b128 v137, v[200:203] offset:21888
    s_add_u32 s16, s42, 1400832
    buffer_load_dwordx4 v[152:155], v143, s[20:23], s16 offen sc1
    s_waitcnt vmcnt(11)
    ds_write_b128 v136, v[204:207] offset:20480
    s_add_u32 s16, s12, 53248
    buffer_load_dwordx4 v[156:159], v142, s[20:23], s16 offen sc1
    s_waitcnt vmcnt(11) lgkmcnt(8)
    ds_write_b128 v137, v[208:211] offset:25536
    s_waitcnt lgkmcnt(0)
    s_mov_b64 exec, 1
    ds_add_u32 v248, v249 offset:8
    s_mov_b64 exec, -1
    s_add_u32 s16, s42, 1517568
    buffer_load_dwordx4 v[160:163], v143, s[20:23], s16 offen sc1
    s_waitcnt vmcnt(11)
    ds_write_b128 v136, v[212:215] offset:24576
    s_add_u32 s16, s12, 57344
    buffer_load_dwordx4 v[164:167], v142, s[20:23], s16 offen sc1
    s_waitcnt vmcnt(11)
    ds_write_b128 v137, v[216:219] offset:29184
    s_add_u32 s16, s42, 1634304
    buffer_load_dwordx4 v[168:171], v143, s[20:23], s16 offen sc1
    s_waitcnt vmcnt(11)
    ds_write_b128 v136, v[220:223] offset:28672
    s_add_u32 s16, s12, 61440
    buffer_load_dwordx4 v[172:175], v142, s[20:23], s16 offen sc1
    s_waitcnt vmcnt(11) lgkmcnt(8)
    ds_write_b128 v137, v[224:227] offset:32832
    s_add_u32 s16, s42, 1751040
    buffer_load_dwordx4 v[176:179], v143, s[20:23], s16 offen sc1
    s_waitcnt vmcnt(11)
    ds_write_b128 v136, v[228:231] offset:32768
    s_add_u32 s16, s12, 65536
    buffer_load_dwordx4 v[180:183], v142, s[20:23], s16 offen sc1
    s_waitcnt vmcnt(11)
    ds_write_b128 v137, v[232:235] offset:36480
    s_add_u32 s16, s42, 1867776
    buffer_load_dwordx4 v[184:187], v143, s[20:23], s16 offen sc1
    s_waitcnt vmcnt(11)
    ds_write_b128 v136, v[236:239] offset:36864
    s_add_u32 s16, s12, 69632
    buffer_load_dwordx4 v[188:191], v142, s[20:23], s16 offen sc1
    s_waitcnt vmcnt(11) lgkmcnt(8)
    ds_write_b128 v137, v[240:243] offset:40128
    s_add_u32 s16, s42, 1984512
    buffer_load_dwordx4 v[192:195], v143, s[20:23], s16 offen sc1
    s_waitcnt vmcnt(11)
    ds_write_b128 v136, v[148:151] offset:40960
    s_add_u32 s16, s42, 2101248
    buffer_load_dwordx4 v[196:199], v143, s[20:23], s16 offen sc1
    s_waitcnt vmcnt(11)
    ds_write_b128 v137, v[152:155] offset:43776
    s_add_u32 s16, s42, 2217984
    buffer_load_dwordx4 v[200:203], v143, s[20:23], s16 offen sc1
    s_waitcnt vmcnt(11)
    ds_write_b128 v136, v[156:159] offset:45056
    s_add_u32 s16, s42, 2334720
    buffer_load_dwordx4 v[204:207], v143, s[20:23], s16 offen sc1
    s_waitcnt vmcnt(11) lgkmcnt(8)
    ds_write_b128 v137, v[160:163] offset:47424
    s_add_u32 s16, s42, 2451456
    buffer_load_dwordx4 v[208:211], v143, s[20:23], s16 offen sc1
    s_waitcnt vmcnt(11)
    ds_write_b128 v136, v[164:167] offset:49152
    s_waitcnt vmcnt(10)
    ds_write_b128 v137, v[168:171] offset:51072
    s_waitcnt vmcnt(9)
    ds_write_b128 v136, v[172:175] offset:53248
    s_waitcnt vmcnt(8) lgkmcnt(8)
    ds_write_b128 v137, v[176:179] offset:54720
    s_waitcnt vmcnt(7)
    ds_write_b128 v136, v[180:183] offset:57344
    s_waitcnt vmcnt(6)
    ds_write_b128 v137, v[184:187] offset:58368
    s_waitcnt vmcnt(5)
    ds_write_b128 v136, v[188:191] offset:61440
    s_waitcnt vmcnt(4) lgkmcnt(8)
    v_add_u32 v1, 62016, v137
    ds_write_b128 v1, v[192:195]
    s_waitcnt vmcnt(3)
    v_add_u32 v1, 65664, v137
    ds_write_b128 v1, v[196:199]
    s_waitcnt vmcnt(2)
    v_add_u32 v1, 69312, v137
    ds_write_b128 v1, v[200:203]
    s_waitcnt vmcnt(1)
    v_add_u32 v1, 72960, v137
    ds_write_b128 v1, v[204:207]
    s_waitcnt vmcnt(0) lgkmcnt(8)
    v_add_u32 v1, 76608, v137
    ds_write_b128 v1, v[208:211]
    s_waitcnt lgkmcnt(0)
    s_mov_b64 exec, 1
    ds_add_u32 v248, v249 offset:12
    s_mov_b64 exec, -1
    buffer_load_dwordx2 v[8:9], v4, s[20:23], s30 offen sc1
    buffer_load_dwordx2 v[10:11], v4, s[20:23], s30 offen offset:512 sc1
    buffer_load_dwordx2 v[12:13], v4, s[20:23], s30 offen offset:1024 sc1
    buffer_load_dwordx2 v[14:15], v4, s[20:23], s30 offen offset:1536 sc1
    buffer_load_dword v16, v138, s[20:23], s31 offen sc1
    s_lshl_b32 s16, s2, 5
    s_lshl_b32 s17, s3, 3
    s_add_u32 s16, s16, s17
    s_add_u32 s16, s16, 9961472
    v_and_b32 v1, 31, v0
    v_cmp_eq_u32 vcc, 0, v1
    v_lshrrev_b32 v1, 3, v0
    v_mov_b32 v67, 0x7ffffff0
    v_cndmask_b32 v67, v67, v1, vcc
    buffer_store_dword v66, v67, s[20:23], s16 offen sc1
    v_and_b32 v1, 31, v0
    v_lshlrev_b32 v5, 2, v1
    v_add_u32 v5, 8192, v5
    v_lshrrev_b32 v6, 5, v0
    v_mul_u32_u24 v6, 304, v6
    v_cmp_eq_u32 vcc, 22, v1
    v_mov_b32 v7, 0xdddddddd
    v_mov_b32 v17, 0
    v_cndmask_b32 v1, v1, 18, vcc
    v_lshl_add_u32 v6, v1, 4, v6
    v_add_u32 v6, 73728, v6
    v_cmp_lt_u32 vcc, 18, v1
    v_mov_b32 v2, 0x28000
    v_mov_b32 v19, 0x3f803f80
    v_mov_b32 v141, 0x3f803f80
    v_cndmask_b32 v6, v6, v2, vcc
    v_mov_b32 v144, 0
    v_mov_b32 v145, 0
    v_mov_b32 v146, 0
    v_mov_b32 v147, 0
    v_mov_b32 v96, 0
    v_mov_b32 v97, 0
    v_mov_b32 v98, 0
    v_mov_b32 v99, 0
    v_mov_b32 v100, 0
    v_mov_b32 v101, 0
    v_mov_b32 v102, 0
    v_mov_b32 v103, 0
    v_mov_b32 v104, 0
    v_mov_b32 v105, 0
    v_mov_b32 v106, 0
    v_mov_b32 v107, 0
    v_mov_b32 v108, 0
    v_mov_b32 v109, 0
    v_mov_b32 v110, 0
    v_mov_b32 v111, 0
    v_mov_b32 v112, 0
    v_mov_b32 v113, 0
    v_mov_b32 v114, 0
    v_mov_b32 v115, 0
    v_mov_b32 v116, 0
    v_mov_b32 v117, 0
    v_mov_b32 v118, 0
    v_mov_b32 v119, 0
    v_mov_b32 v120, 0
    v_mov_b32 v121, 0
    v_mov_b32 v122, 0
    v_mov_b32 v123, 0
    v_mov_b32 v124, 0
    v_mov_b32 v125, 0
    v_mov_b32 v126, 0
    v_mov_b32 v127, 0
    v_mov_b32 v88, 0
    v_mov_b32 v89, 0
    v_mov_b32 v90, 0
    v_mov_b32 v91, 0
    v_mov_b32 v92, 0
    v_mov_b32 v93, 0
    v_mov_b32 v94, 0
    v_mov_b32 v95, 0
    s_cmp_ge_u32 s2, 162
    s_cbranch_scc1 K2_NOWF
    s_mov_b32 s34, 0x05040100
    s_mov_b32 s35, 0x07060302
    s_lshr_b32 s30, s67, 4
    s_lshl_b32 s30, s30, 1
    s_add_u32 s30, s30, s67
    s_bfe_u32 s36, s67, 0x10001
    s_lshl_b32 s36, s36, 4
    s_add_u32 s36, s36, s67
    s_sub_u32 s36, s36, 16
    s_cmp_lt_u32 s67, 32
    s_cselect_b32 s30, s30, s36
    s_mul_i32 s30, s30, 4608
    s_add_u32 s30, s30, 10485760
    s_lshl_b32 s36, s68, 2
    v_bfe_u32 v1, v0, 3, 1
    v_lshl_add_u32 v1, v1, 1, s36
    v_lshrrev_b32 v2, 4, v0
    v_lshlrev_b32 v2, 7, v2
    v_and_b32 v3, 3, v0
    v_lshl_add_u32 v2, v3, 5, v2
    v_bfe_u32 v3, v0, 2, 1
    v_lshl_add_u32 v2, v3, 4, v2
    v_mul_u32_u24 v128, 7282, v1
    v_lshrrev_b32 v128, 16, v128
    v_mul_u32_u24 v128, 161280, v128
    v_lshl_add_u32 v128, v1, 9, v128
    v_add_u32 v128, v128, v2
    v_add_u32 v1, 1, v1
    v_xor_b32 v2, 16, v2
    v_mul_u32_u24 v129, 7282, v1
    v_lshrrev_b32 v129, 16, v129
    v_mul_u32_u24 v129, 161280, v129
    v_lshl_add_u32 v129, v1, 9, v129
    v_add_u32 v129, v129, v2
    v_perm_b32 v40, v33, v32, s34
    v_perm_b32 v48, v33, v32, s35
    v_mov_b32 v44, v40
    v_perm_b32 v41, v35, v34, s34
    v_perm_b32 v49, v35, v34, s35
    v_mov_b32 v45, v41
    v_perm_b32 v42, v37, v36, s34
    v_perm_b32 v50, v37, v36, s35
    v_mov_b32 v46, v42
    v_perm_b32 v43, v39, v38, s34
    v_perm_b32 v51, v39, v38, s35
    v_mov_b32 v47, v43
    s_nop 1
    v_mov_b32_dpp v40, v48 row_shr:4 row_mask:0xf bank_mask:0xa
    v_mov_b32_dpp v44, v48 row_shl:4 row_mask:0xf bank_mask:0x5
    v_mov_b32_dpp v41, v49 row_shr:4 row_mask:0xf bank_mask:0xa
    v_mov_b32_dpp v45, v49 row_shl:4 row_mask:0xf bank_mask:0x5
    v_mov_b32_dpp v42, v50 row_shr:4 row_mask:0xf bank_mask:0xa
    v_mov_b32_dpp v46, v50 row_shl:4 row_mask:0xf bank_mask:0x5
    v_mov_b32_dpp v43, v51 row_shr:4 row_mask:0xf bank_mask:0xa
    v_mov_b32_dpp v47, v51 row_shl:4 row_mask:0xf bank_mask:0x5
    buffer_store_dwordx4 v[40:43], v128, s[20:23], s30 offen sc1
    buffer_store_dwordx4 v[44:47], v129, s[20:23], s30 offen sc1
K2_NOWF:
    s_mov_b32 s16, 0
K2_WS3:
    ds_read_b32 v1, v248 offset:12
    s_add_u32 s16, s16, 1
    s_waitcnt lgkmcnt(0)
    v_readfirstlane_b32 s17, v1
    s_cmp_ge_u32 s16, 0x400000
    s_cbranch_scc1 K2_WS3D
    s_cmp_ge_u32 s17, 4
    s_cbranch_scc1 K2_WS3D
    s_sleep 1
    s_branch K2_WS3
K2_WS3D:
    s_waitcnt vmcnt(0)
    s_mov_b64 exec, 1
    ds_add_rtn_u32 v129, v248, v249
    v_mov_b32 v1, 0
    s_waitcnt lgkmcnt(0)
    v_readfirstlane_b32 s30, v129
    s_mov_b32 s40, 4
    s_nop 2
    s_cmp_lg_u32 s30, 3
    s_cbranch_scc1 K2_STG2
    buffer_atomic_add v249, v1, s[48:51], 0 offen
K2_STG2:
    s_mov_b64 exec, -1
K2_PRO:
    ds_read_b32 v18, v5 offset:0
    ds_read2st64_b64 v[20:23], v4 offset0:0 offset1:1
    ds_read_b32 v140, v5 offset:128
    ds_read_b128 v[24:27], v6 offset:0
    ds_read_b128 v[28:31], v6 offset:608
    s_waitcnt lgkmcnt(3)
    v_mfma_f32_32x32x4_2b_bf16 v[32:63], v[18:19], v[16:17], 0
    s_nop 15
    s_nop 1
    v_mfma_f32_32x32x16_bf16 v[32:47], v[20:23], v[8:11], v[32:47]
    v_mfma_f32_32x32x16_bf16 v[48:63], v[20:23], v[12:15], v[48:63]
    s_nop 10
    v_max3_f32 v134, v32, v33, v34
    v_max3_f32 v134, v134, v35, v36
    v_max3_f32 v134, v134, v37, v38
    v_max3_f32 v134, v134, v39, v40
    v_max3_f32 v134, v134, v41, v42
    v_max3_f32 v134, v134, v43, v44
    v_max3_f32 v134, v134, v45, v46
    v_max3_f32 v134, v134, v47, v47
    v_max3_f32 v135, v48, v49, v50
    v_max3_f32 v135, v135, v51, v52
    v_max3_f32 v135, v135, v53, v54
    v_max3_f32 v135, v135, v55, v56
    v_max3_f32 v135, v135, v57, v58
    v_max3_f32 v135, v135, v59, v60
    v_max3_f32 v135, v135, v61, v62
    v_max3_f32 v135, v135, v63, v63
    s_nop 1
    v_permlane32_swap_b32 v134, v135
    s_nop 1
    v_max_f32 v134, v134, v135
    v_cvt_pk_bf16_f32 v17, -v134, 0
    s_waitcnt lgkmcnt(0)
    s_nop 0
    v_mfma_f32_32x32x4_2b_bf16 v[32:63], v[18:19], v[16:17], 0
    ds_read_b32 v18, v5 offset:256
    s_nop 15
    s_nop 0
    v_mfma_f32_32x32x16_bf16 v[32:47], v[20:23], v[8:11], v[32:47]
    v_mfma_f32_32x32x16_bf16 v[48:63], v[20:23], v[12:15], v[48:63]
    ds_read2st64_b64 v[20:23], v4 offset0:2 offset1:3
    s_mov_b32 s18, 0
    s_cmp_ge_u32 s3, 4
    s_cbranch_scc1 K2_PR1
    s_setprio 0
K2_PR1:
    s_nop 7
.p2align 6
K2_LOOP:
    s_cmp_lg_u32 s18, 6
    s_cbranch_scc1 K2_PK
    s_setprio 0
K2_PK:
    v_exp_f32 v32, v32
    v_exp_f32 v33, v33
    v_smfmac_f32_32x32x32_bf16 v[112:127], v[144:147], v[88:95], v7
    v_exp_f32 v34, v34
    v_exp_f32 v35, v35
    v_exp_f32 v36, v36
    v_mfma_f32_32x32x4_2b_bf16 v[64:95], v[140:141], v[16:17], 0
    ds_read_b32 v140, v5 offset:384
    v_exp_f32 v37, v37
    v_exp_f32 v38, v38
    v_exp_f32 v39, v39
    v_exp_f32 v40, v40
    v_exp_f32 v41, v41
    v_exp_f32 v42, v42
    v_exp_f32 v43, v43
    v_exp_f32 v44, v44
    s_waitcnt lgkmcnt(1)
    v_smfmac_f32_32x32x32_bf16 v[96:111], v[24:27], v[32:39], v7
    v_exp_f32 v45, v45
    v_exp_f32 v46, v46
    v_exp_f32 v47, v47
    v_exp_f32 v48, v48
    v_exp_f32 v49, v49
    v_smfmac_f32_32x32x32_bf16 v[96:111], v[28:31], v[40:47], v7
    v_exp_f32 v50, v50
    v_exp_f32 v51, v51
    v_exp_f32 v52, v52
    v_mfma_f32_32x32x16_bf16 v[64:79], v[20:23], v[8:11], v[64:79]
    v_exp_f32 v53, v53
    v_exp_f32 v54, v54
    v_exp_f32 v55, v55
    v_mfma_f32_32x32x16_bf16 v[80:95], v[20:23], v[12:15], v[80:95]
    ds_read2st64_b64 v[20:23], v4 offset0:4 offset1:5
    v_exp_f32 v56, v56
    v_exp_f32 v57, v57
    v_exp_f32 v58, v58
    v_smfmac_f32_32x32x32_bf16 v[112:127], v[24:27], v[48:55], v7
    ds_read_b128 v[24:27], v6 offset:1216
    ds_read_b128 v[144:147], v6 offset:1824
    v_exp_f32 v59, v59
    v_exp_f32 v60, v60
    v_exp_f32 v61, v61
    v_exp_f32 v62, v62
    v_exp_f32 v63, v63
    v_exp_f32 v64, v64
    v_exp_f32 v65, v65
    v_smfmac_f32_32x32x32_bf16 v[112:127], v[28:31], v[56:63], v7
    v_exp_f32 v66, v66
    v_exp_f32 v67, v67
    v_exp_f32 v68, v68
    v_mfma_f32_32x32x4_2b_bf16 v[32:63], v[18:19], v[16:17], 0
    ds_read_b32 v18, v5 offset:512
    v_exp_f32 v69, v69
    v_exp_f32 v70, v70
    v_exp_f32 v71, v71
    v_exp_f32 v72, v72
    v_exp_f32 v73, v73
    v_exp_f32 v74, v74
    v_exp_f32 v75, v75
    v_exp_f32 v76, v76
    s_waitcnt lgkmcnt(1)
    v_smfmac_f32_32x32x32_bf16 v[96:111], v[24:27], v[64:71], v7
    v_exp_f32 v77, v77
    v_exp_f32 v78, v78
    v_exp_f32 v79, v79
    v_exp_f32 v80, v80
    v_exp_f32 v81, v81
    v_smfmac_f32_32x32x32_bf16 v[96:111], v[144:147], v[72:79], v7
    v_exp_f32 v82, v82
    v_exp_f32 v83, v83
    v_exp_f32 v84, v84
    v_mfma_f32_32x32x16_bf16 v[32:47], v[20:23], v[8:11], v[32:47]
    v_exp_f32 v85, v85
    v_exp_f32 v86, v86
    v_exp_f32 v87, v87
    v_mfma_f32_32x32x16_bf16 v[48:63], v[20:23], v[12:15], v[48:63]
    ds_read2st64_b64 v[20:23], v4 offset0:6 offset1:7
    v_exp_f32 v88, v88
    v_exp_f32 v89, v89
    v_exp_f32 v90, v90
    v_smfmac_f32_32x32x32_bf16 v[112:127], v[24:27], v[80:87], v7
    ds_read_b128 v[24:27], v6 offset:2432
    ds_read_b128 v[28:31], v6 offset:3040
    v_exp_f32 v91, v91
    v_exp_f32 v92, v92
    v_exp_f32 v93, v93
    v_exp_f32 v94, v94
    v_exp_f32 v95, v95
    v_exp_f32 v32, v32
    v_exp_f32 v33, v33
    v_smfmac_f32_32x32x32_bf16 v[112:127], v[144:147], v[88:95], v7
    v_exp_f32 v34, v34
    v_exp_f32 v35, v35
    v_exp_f32 v36, v36
    v_mfma_f32_32x32x4_2b_bf16 v[64:95], v[140:141], v[16:17], 0
    ds_read_b32 v140, v5 offset:640
    v_exp_f32 v37, v37
    v_exp_f32 v38, v38
    v_exp_f32 v39, v39
    v_exp_f32 v40, v40
    v_exp_f32 v41, v41
    v_exp_f32 v42, v42
    v_exp_f32 v43, v43
    v_exp_f32 v44, v44
    s_waitcnt lgkmcnt(1)
    v_smfmac_f32_32x32x32_bf16 v[96:111], v[24:27], v[32:39], v7
    v_exp_f32 v45, v45
    v_exp_f32 v46, v46
    v_exp_f32 v47, v47
    v_exp_f32 v48, v48
    v_exp_f32 v49, v49
    v_smfmac_f32_32x32x32_bf16 v[96:111], v[28:31], v[40:47], v7
    v_exp_f32 v50, v50
    v_exp_f32 v51, v51
    v_exp_f32 v52, v52
    v_mfma_f32_32x32x16_bf16 v[64:79], v[20:23], v[8:11], v[64:79]
    v_exp_f32 v53, v53
    v_exp_f32 v54, v54
    v_exp_f32 v55, v55
    v_mfma_f32_32x32x16_bf16 v[80:95], v[20:23], v[12:15], v[80:95]
    ds_read2st64_b64 v[20:23], v4 offset0:8 offset1:9
    v_exp_f32 v56, v56
    v_exp_f32 v57, v57
    v_exp_f32 v58, v58
    v_smfmac_f32_32x32x32_bf16 v[112:127], v[24:27], v[48:55], v7
    ds_read_b128 v[24:27], v6 offset:3648
    ds_read_b128 v[144:147], v6 offset:4256
    v_exp_f32 v59, v59
    v_exp_f32 v60, v60
    v_exp_f32 v61, v61
    v_exp_f32 v62, v62
    v_exp_f32 v63, v63
    v_exp_f32 v64, v64
    v_exp_f32 v65, v65
    v_smfmac_f32_32x32x32_bf16 v[112:127], v[28:31], v[56:63], v7
    v_exp_f32 v66, v66
    v_exp_f32 v67, v67
    v_exp_f32 v68, v68
    v_mfma_f32_32x32x4_2b_bf16 v[32:63], v[18:19], v[16:17], 0
    ds_read_b32 v18, v5 offset:768
    v_exp_f32 v69, v69
    v_exp_f32 v70, v70
    v_exp_f32 v71, v71
    v_exp_f32 v72, v72
    v_exp_f32 v73, v73
    v_exp_f32 v74, v74
    v_exp_f32 v75, v75
    v_exp_f32 v76, v76
    s_waitcnt lgkmcnt(1)
    v_smfmac_f32_32x32x32_bf16 v[96:111], v[24:27], v[64:71], v7
    v_exp_f32 v77, v77
    v_exp_f32 v78, v78
    v_exp_f32 v79, v79
    v_exp_f32 v80, v80
    v_exp_f32 v81, v81
    v_smfmac_f32_32x32x32_bf16 v[96:111], v[144:147], v[72:79], v7
    v_exp_f32 v82, v82
    v_exp_f32 v83, v83
    v_exp_f32 v84, v84
    v_mfma_f32_32x32x16_bf16 v[32:47], v[20:23], v[8:11], v[32:47]
    v_exp_f32 v85, v85
    v_exp_f32 v86, v86
    v_exp_f32 v87, v87
    v_mfma_f32_32x32x16_bf16 v[48:63], v[20:23], v[12:15], v[48:63]
    ds_read2st64_b64 v[20:23], v4 offset0:10 offset1:11
    v_exp_f32 v88, v88
    v_exp_f32 v89, v89
    v_exp_f32 v90, v90
    v_smfmac_f32_32x32x32_bf16 v[112:127], v[24:27], v[80:87], v7
    ds_read_b128 v[24:27], v6 offset:4864
    ds_read_b128 v[28:31], v6 offset:5472
    v_exp_f32 v91, v91
    v_exp_f32 v92, v92
    v_exp_f32 v93, v93
    v_exp_f32 v94, v94
    v_exp_f32 v95, v95
    v_exp_f32 v32, v32
    v_exp_f32 v33, v33
    v_smfmac_f32_32x32x32_bf16 v[112:127], v[144:147], v[88:95], v7
    v_exp_f32 v34, v34
    v_exp_f32 v35, v35
    v_exp_f32 v36, v36
    v_mfma_f32_32x32x4_2b_bf16 v[64:95], v[140:141], v[16:17], 0
    ds_read_b32 v140, v5 offset:896
    v_exp_f32 v37, v37
    v_exp_f32 v38, v38
    v_exp_f32 v39, v39
    v_exp_f32 v40, v40
    v_exp_f32 v41, v41
    v_exp_f32 v42, v42
    v_exp_f32 v43, v43
    v_exp_f32 v44, v44
    s_waitcnt lgkmcnt(1)
    v_smfmac_f32_32x32x32_bf16 v[96:111], v[24:27], v[32:39], v7
    v_exp_f32 v45, v45
    v_exp_f32 v46, v46
    v_exp_f32 v47, v47
    v_exp_f32 v48, v48
    v_exp_f32 v49, v49
    v_smfmac_f32_32x32x32_bf16 v[96:111], v[28:31], v[40:47], v7
    v_exp_f32 v50, v50
    v_exp_f32 v51, v51
    v_exp_f32 v52, v52
    v_mfma_f32_32x32x16_bf16 v[64:79], v[20:23], v[8:11], v[64:79]
    v_exp_f32 v53, v53
    v_exp_f32 v54, v54
    v_exp_f32 v55, v55
    v_mfma_f32_32x32x16_bf16 v[80:95], v[20:23], v[12:15], v[80:95]
    ds_read2st64_b64 v[20:23], v4 offset0:12 offset1:13
    v_exp_f32 v56, v56
    v_exp_f32 v57, v57
    v_exp_f32 v58, v58
    v_smfmac_f32_32x32x32_bf16 v[112:127], v[24:27], v[48:55], v7
    ds_read_b128 v[24:27], v6 offset:6080
    ds_read_b128 v[144:147], v6 offset:6688
    v_exp_f32 v59, v59
    v_exp_f32 v60, v60
    v_exp_f32 v61, v61
    v_exp_f32 v62, v62
    v_exp_f32 v63, v63
    s_cmp_eq_u32 s18, s40
    s_cbranch_scc1 K2_SYNC1
K2_SYNC_RET:
    v_exp_f32 v64, v64
    v_exp_f32 v65, v65
    v_smfmac_f32_32x32x32_bf16 v[112:127], v[28:31], v[56:63], v7
    v_exp_f32 v66, v66
    v_exp_f32 v67, v67
    v_exp_f32 v68, v68
    v_mfma_f32_32x32x4_2b_bf16 v[32:63], v[18:19], v[16:17], 0
    ds_read_b32 v18, v5 offset:9216
    v_exp_f32 v69, v69
    v_exp_f32 v70, v70
    v_exp_f32 v71, v71
    v_exp_f32 v72, v72
    v_exp_f32 v73, v73
    v_exp_f32 v74, v74
    v_exp_f32 v75, v75
    v_exp_f32 v76, v76
    s_waitcnt lgkmcnt(1)
    v_smfmac_f32_32x32x32_bf16 v[96:111], v[24:27], v[64:71], v7
    v_exp_f32 v77, v77
    v_exp_f32 v78, v78
    v_exp_f32 v79, v79
    v_exp_f32 v80, v80
    v_exp_f32 v81, v81
    v_smfmac_f32_32x32x32_bf16 v[96:111], v[144:147], v[72:79], v7
    v_exp_f32 v82, v82
    v_exp_f32 v83, v83
    v_exp_f32 v84, v84
    v_mfma_f32_32x32x16_bf16 v[32:47], v[20:23], v[8:11], v[32:47]
    v_exp_f32 v85, v85
    v_exp_f32 v86, v86
    v_exp_f32 v87, v87
    v_mfma_f32_32x32x16_bf16 v[48:63], v[20:23], v[12:15], v[48:63]
    ds_read2st64_b64 v[20:23], v4 offset0:14 offset1:15
    v_exp_f32 v88, v88
    v_exp_f32 v89, v89
    v_exp_f32 v90, v90
    v_smfmac_f32_32x32x32_bf16 v[112:127], v[24:27], v[80:87], v7
    ds_read_b128 v[24:27], v6 offset:7296
    ds_read_b128 v[28:31], v6 offset:7904
    v_exp_f32 v91, v91
    v_exp_f32 v92, v92
    v_exp_f32 v93, v93
    v_exp_f32 v94, v94
    v_exp_f32 v95, v95
    v_exp_f32 v32, v32
    v_exp_f32 v33, v33
    v_smfmac_f32_32x32x32_bf16 v[112:127], v[144:147], v[88:95], v7
    v_exp_f32 v34, v34
    v_exp_f32 v35, v35
    v_exp_f32 v36, v36
    v_mfma_f32_32x32x4_2b_bf16 v[64:95], v[140:141], v[16:17], 0
    ds_read_b32 v140, v5 offset:9344
    v_exp_f32 v37, v37
    v_exp_f32 v38, v38
    v_exp_f32 v39, v39
    v_exp_f32 v40, v40
    v_exp_f32 v41, v41
    v_exp_f32 v42, v42
    v_exp_f32 v43, v43
    v_exp_f32 v44, v44
    s_waitcnt lgkmcnt(1)
    v_smfmac_f32_32x32x32_bf16 v[96:111], v[24:27], v[32:39], v7
    v_exp_f32 v45, v45
    v_exp_f32 v46, v46
    v_exp_f32 v47, v47
    v_exp_f32 v48, v48
    v_exp_f32 v49, v49
    v_smfmac_f32_32x32x32_bf16 v[96:111], v[28:31], v[40:47], v7
    v_exp_f32 v50, v50
    v_exp_f32 v51, v51
    v_exp_f32 v52, v52
    v_mfma_f32_32x32x16_bf16 v[64:79], v[20:23], v[8:11], v[64:79]
    v_exp_f32 v53, v53
    v_exp_f32 v54, v54
    v_exp_f32 v55, v55
    v_mfma_f32_32x32x16_bf16 v[80:95], v[20:23], v[12:15], v[80:95]
    ds_read2st64_b64 v[20:23], v4 offset0:18 offset1:19
    v_exp_f32 v56, v56
    v_exp_f32 v57, v57
    v_exp_f32 v58, v58
    v_smfmac_f32_32x32x32_bf16 v[112:127], v[24:27], v[48:55], v7
    ds_read_b128 v[24:27], v6 offset:8512
    ds_read_b128 v[144:147], v6 offset:9120
    v_exp_f32 v59, v59
    v_exp_f32 v60, v60
    v_exp_f32 v61, v61
    v_exp_f32 v62, v62
    v_exp_f32 v63, v63
    v_exp_f32 v64, v64
    v_exp_f32 v65, v65
    v_smfmac_f32_32x32x32_bf16 v[112:127], v[28:31], v[56:63], v7
    v_exp_f32 v66, v66
    v_exp_f32 v67, v67
    v_exp_f32 v68, v68
    v_mfma_f32_32x32x4_2b_bf16 v[32:63], v[18:19], v[16:17], 0
    ds_read_b32 v18, v5 offset:9472
    v_exp_f32 v69, v69
    v_exp_f32 v70, v70
    v_exp_f32 v71, v71
    v_exp_f32 v72, v72
    v_exp_f32 v73, v73
    v_exp_f32 v74, v74
    v_exp_f32 v75, v75
    v_exp_f32 v76, v76
    s_waitcnt lgkmcnt(1)
    v_smfmac_f32_32x32x32_bf16 v[96:111], v[24:27], v[64:71], v7
    v_exp_f32 v77, v77
    v_exp_f32 v78, v78
    v_exp_f32 v79, v79
    v_exp_f32 v80, v80
    v_exp_f32 v81, v81
    v_smfmac_f32_32x32x32_bf16 v[96:111], v[144:147], v[72:79], v7
    v_exp_f32 v82, v82
    v_exp_f32 v83, v83
    v_exp_f32 v84, v84
    v_mfma_f32_32x32x16_bf16 v[32:47], v[20:23], v[8:11], v[32:47]
    v_exp_f32 v85, v85
    v_exp_f32 v86, v86
    v_exp_f32 v87, v87
    v_mfma_f32_32x32x16_bf16 v[48:63], v[20:23], v[12:15], v[48:63]
    ds_read2st64_b64 v[20:23], v4 offset0:20 offset1:21
    v_exp_f32 v88, v88
    v_exp_f32 v89, v89
    v_exp_f32 v90, v90
    v_smfmac_f32_32x32x32_bf16 v[112:127], v[24:27], v[80:87], v7
    ds_read_b128 v[24:27], v6 offset:9728
    ds_read_b128 v[28:31], v6 offset:10336
    v_add_u32 v4, 9216, v4
    v_add_u32 v5, 9216, v5
    v_add_u32 v6, 9728, v6
    s_add_u32 s18, s18, 1
    s_cmp_lt_u32 s18, 8
    v_exp_f32 v91, v91
    v_exp_f32 v92, v92
    v_exp_f32 v93, v93
    v_exp_f32 v94, v94
    v_exp_f32 v95, v95
    s_cbranch_scc1 K2_LOOP
    s_nop 1
    v_smfmac_f32_32x32x32_bf16 v[112:127], v[144:147], v[88:95], v7
    s_mov_b32 s19, 0
    s_waitcnt vmcnt(0) lgkmcnt(0)
    s_nop 10
K2_FIN:
    s_cmp_lg_u32 s19, 0
    s_cbranch_scc1 K2_OUT
    v_max_f32 v32, v106, v122
    v_mov_b32 v33, 0
    v_fmac_f32 v32, v96, v33
    v_fmac_f32 v32, v112, v33
    v_fmac_f32 v32, v97, v33
    v_fmac_f32 v32, v113, v33
    v_fmac_f32 v32, v98, v33
    v_fmac_f32 v32, v114, v33
    v_fmac_f32 v32, v99, v33
    v_fmac_f32 v32, v115, v33
    v_fmac_f32 v32, v100, v33
    v_fmac_f32 v32, v116, v33
    v_fmac_f32 v32, v101, v33
    v_fmac_f32 v32, v117, v33
    v_fmac_f32 v32, v102, v33
    v_fmac_f32 v32, v118, v33
    v_fmac_f32 v32, v103, v33
    v_fmac_f32 v32, v119, v33
    v_fmac_f32 v32, v104, v33
    v_fmac_f32 v32, v120, v33
    v_fmac_f32 v32, v105, v33
    v_fmac_f32 v32, v121, v33
    v_fmac_f32 v32, v106, v33
    v_fmac_f32 v32, v122, v33
    v_min_f32 v34, v106, v122
    v_mov_b32 v33, 0x4e800000
    v_cmp_nlt_f32 s[30:31], v32, v33
    v_cmp_nlt_f32 vcc, 0x30800000, v34
    s_nop 4
    s_or_b64 vcc, vcc, s[30:31]
    s_cbranch_scc1 K2_SLOW
K2_OUT:
    s_cmp_lt_u32 s10, 32
    s_cbranch_scc1 K2_GA
    v_sub_f32 v2, 1.0, v2
    v_sub_f32 v3, 1.0, v3
K2_GA:
    v_rcp_f32 v32, v106
    v_rcp_f32 v33, v122
    s_nop 0
    v_mul_f32 v32, v32, v2
    v_mul_f32 v33, v33, v3
    v_mul_f32 v96, v96, v32
    v_mul_f32 v97, v97, v32
    v_mul_f32 v98, v98, v32
    v_mul_f32 v99, v99, v32
    v_mul_f32 v100, v100, v32
    v_mul_f32 v101, v101, v32
    v_mul_f32 v102, v102, v32
    v_mul_f32 v103, v103, v32
    v_mul_f32 v104, v104, v32
    v_mul_f32 v105, v105, v32
    v_cvt_pk_bf16_f32 v36, v96, v97
    v_cvt_pk_bf16_f32 v37, v98, v99
    v_cvt_pk_bf16_f32 v38, v100, v101
    v_cvt_pk_bf16_f32 v39, v102, v103
    v_cvt_pk_bf16_f32 v40, v104, v105
    v_mul_f32 v112, v112, v33
    v_mul_f32 v113, v113, v33
    v_mul_f32 v114, v114, v33
    v_mul_f32 v115, v115, v33
    v_mul_f32 v116, v116, v33
    v_mul_f32 v117, v117, v33
    v_mul_f32 v118, v118, v33
    v_mul_f32 v119, v119, v33
    v_mul_f32 v120, v120, v33
    v_mul_f32 v121, v121, v33
    v_cvt_pk_bf16_f32 v44, v112, v113
    v_cvt_pk_bf16_f32 v45, v114, v115
    v_cvt_pk_bf16_f32 v46, v116, v117
    v_cvt_pk_bf16_f32 v47, v118, v119
    v_cvt_pk_bf16_f32 v48, v120, v121
    v_bfe_u32 v34, v0, 4, 1
    v_lshlrev_b32 v34, 15, v34
    v_and_b32 v35, 15, v0
    v_lshl_add_u32 v34, v35, 4, v34
    v_lshrrev_b32 v35, 5, v0
    v_lshl_add_u32 v52, v35, 8, v34
    v_lshlrev_b32 v53, 2, v0
    s_lshl_b32 s16, s14, 16
    s_lshl_b32 s17, s10, 9
    s_add_u32 s17, s17, s16
    s_add_u32 s17, s17, 12582912
    v_permlane32_swap_b32 v40, v48
    s_lshl_b32 s30, s10, 13
    s_lshl_b32 s31, s14, 7
    s_add_u32 s30, s30, s31
    s_add_u32 s30, s30, 16777216
    buffer_store_dwordx4 v[36:39], v52, s[20:23], s17 offen sc1
    s_add_u32 s17, s17, 65536
    buffer_store_dword v40, v53, s[20:23], s30 offen sc1
    buffer_store_dwordx4 v[44:47], v52, s[20:23], s17 offen sc1
    s_setprio 0
    v_add_u32 v4, s13, v142
    s_mov_b32 s27, 0x00020000
    s_lshl_b32 s16, s14, 5
    s_add_u32 s16, s16, s10
    s_lshl_b32 s16, s16, 7
    s_add_u32 s70, s16, 17825792
    v_cmp_gt_u32 vcc, 32, v0
    v_mov_b32 v5, 0x7ffffff0
    v_mov_b32 v6, s71
    v_cndmask_b32 v5, v5, v138, vcc
    s_waitcnt vmcnt(0)
    buffer_store_dword v6, v5, s[20:23], s70 offen sc1
    s_barrier
    ds_write_b128 v4, v[148:151] offset:0
    ds_write_b128 v4, v[152:155] offset:8192
    ds_write_b128 v4, v[156:159] offset:16384
    ds_write_b128 v4, v[160:163] offset:24576
    ds_write_b128 v4, v[164:167] offset:32768
    ds_write_b128 v4, v[168:171] offset:40960
    ds_write_b128 v4, v[172:175] offset:49152
    ds_write_b128 v4, v[176:179] offset:57344
    v_add_u32 v4, 65536, v4
    ds_write_b128 v4, v[180:183] offset:0
    ds_write_b128 v4, v[184:187] offset:8192
    s_waitcnt lgkmcnt(4)
    ds_write_b128 v4, v[188:191] offset:16384
    ds_write_b128 v4, v[192:195] offset:24576
    ds_write_b128 v4, v[196:199] offset:32768
    ds_write_b128 v4, v[200:203] offset:40960
    ds_write_b128 v4, v[204:207] offset:49152
    ds_write_b128 v4, v[208:211] offset:57344
    v_add_u32 v4, 65536, v4
    ds_write_b128 v4, v[212:215] offset:0
    ds_write_b128 v4, v[216:219] offset:8192
    ds_write_b128 v4, v[220:223] offset:16384
    ds_write_b128 v4, v[224:227] offset:24576
    s_cmp_lg_u32 s3, 0
    s_cbranch_scc1 K2_NOPOLL
    s_lshl_b32 s16, s45, 13
    s_add_u32 s16, s16, 17825792
    v_lshlrev_b32 v5, 7, v0
    s_mov_b32 s17, 0
K2_POLL:
    buffer_load_dword v6, v5, s[20:23], s16 offen sc1
    s_add_u32 s17, s17, 1
    s_waitcnt vmcnt(0)
    v_cmp_ne_u32 vcc, s71, v6
    s_cmp_ge_u32 s17, 0x40000
    s_cbranch_scc1 K2_NOPOLL
    s_nop 1
    s_cmp_eq_u64 vcc, 0
    s_cbranch_scc1 K2_NOPOLL
    s_sleep 4
    s_branch K2_POLL
K2_NOPOLL:
    s_and_b32 s47, s3, 3
    s_lshr_b32 s48, s3, 2
    s_lshl_b32 s12, s45, 2
    s_add_u32 s12, s12, s47
    s_mul_i32 s14, s12, 18432
    s_mul_i32 s17, s46, 144
    s_add_u32 s14, s14, s17
    s_lshl_b32 s15, s12, 6
    s_lshl_b32 s17, s48, 18
    s_add_u32 s15, s15, s17
    s_add_u32 s15, s15, 16777216
    s_lshl_b32 s12, s12, 15
    s_lshl_b32 s17, s48, 14
    s_add_u32 s12, s12, s17
    s_add_u32 s12, s12, 12582912
    s_mul_i32 s49, s48, 82944
    s_mov_b32 s24, s6
    s_mov_b32 s25, s7
    s_mov_b32 s26, 2359296
    v_lshrrev_b32 v3, 4, v0
    v_lshlrev_b32 v2, 7, v3
    v_and_b32 v4, 7, v0
    v_lshl_add_u32 v2, v4, 4, v2
    v_bfe_u32 v4, v0, 3, 1
    v_lshl_add_u32 v2, v4, 9, v2
    v_add_u32 v2, s49, v2
    v_and_b32 v6, 15, v0
    v_mul_u32_u24 v5, 1152, v6
    v_lshlrev_b32 v6, 2, v6
    v_lshl_add_u32 v1, v3, 15, v6
    v_lshl_add_u32 v5, v3, 3, v5
    v_mov_b32 v6, 0x7ffffff0
    v_cmp_gt_u32 vcc, 2, v3
    v_and_b32 v7, 1, v3
    v_mul_u32_u24 v7, 24, v7
    v_cndmask_b32 v6, v6, v5, vcc
    v_add_u32 v7, v7, v5
    s_add_u32 s16, s46, 0
    s_and_b32 s16, s16, 7
    s_lshl_b32 s52, s16, 11
    s_add_u32 s52, s52, s12
    s_mul_i32 s60, s16, 9216
    s_add_u32 s16, s46, 1
    s_and_b32 s16, s16, 7
    s_lshl_b32 s53, s16, 11
    s_add_u32 s53, s53, s12
    s_mul_i32 s61, s16, 9216
    s_add_u32 s16, s46, 2
    s_and_b32 s16, s16, 7
    s_lshl_b32 s54, s16, 11
    s_add_u32 s54, s54, s12
    s_mul_i32 s62, s16, 9216
    s_add_u32 s16, s46, 3
    s_and_b32 s16, s16, 7
    s_lshl_b32 s55, s16, 11
    s_add_u32 s55, s55, s12
    s_mul_i32 s63, s16, 9216
    s_add_u32 s16, s46, 4
    s_and_b32 s16, s16, 7
    s_lshl_b32 s56, s16, 11
    s_add_u32 s56, s56, s12
    s_mul_i32 s64, s16, 9216
    s_add_u32 s16, s46, 5
    s_and_b32 s16, s16, 7
    s_lshl_b32 s57, s16, 11
    s_add_u32 s57, s57, s12
    s_mul_i32 s65, s16, 9216
    s_add_u32 s16, s46, 6
    s_and_b32 s16, s16, 7
    s_lshl_b32 s58, s16, 11
    s_add_u32 s58, s58, s12
    s_mul_i32 s66, s16, 9216
    s_add_u32 s16, s46, 7
    s_and_b32 s16, s16, 7
    s_lshl_b32 s59, s16, 11
    s_add_u32 s59, s59, s12
    s_mul_i32 s67, s16, 9216
    s_waitcnt lgkmcnt(0)
    s_barrier
    buffer_load_dwordx4 v[8:11], v142, s[20:23], s52 offen offset:0 sc1
    buffer_load_dwordx4 v[12:15], v142, s[20:23], s52 offen offset:1024 sc1
    buffer_load_dwordx4 v[16:19], v142, s[20:23], s53 offen offset:0 sc1
    buffer_load_dwordx4 v[20:23], v142, s[20:23], s53 offen offset:1024 sc1
    buffer_load_dwordx4 v[24:27], v142, s[20:23], s54 offen offset:0 sc1
    buffer_load_dwordx4 v[28:31], v142, s[20:23], s54 offen offset:1024 sc1
    v_add_u32 v4, s60, v2
    ds_read_b128 v[148:151], v4 offset:0
    ds_read_b128 v[152:155], v4 offset:1024
    ds_read_b128 v[156:159], v4 offset:2048
    ds_read_b128 v[160:163], v4 offset:3072
    ds_read_b128 v[164:167], v4 offset:4096
    ds_read_b128 v[168:171], v4 offset:4608
    ds_read_b128 v[172:175], v4 offset:5632
    ds_read_b128 v[176:179], v4 offset:6656
    ds_read_b128 v[180:183], v4 offset:7680
    ds_read_b128 v[184:187], v4 offset:8704
    s_waitcnt vmcnt(5) lgkmcnt(5)
    v_mfma_f32_16x16x32_bf16 v[208:211], v[148:151], v[8:11], 0
    v_add_u32 v4, s61, v2
    ds_read_b128 v[188:191], v4 offset:0
    buffer_load_dwordx4 v[32:35], v142, s[20:23], s55 offen offset:0 sc1
    v_mfma_f32_16x16x32_bf16 v[212:215], v[152:155], v[8:11], 0
    ds_read_b128 v[192:195], v4 offset:1024
    v_mfma_f32_16x16x32_bf16 v[216:219], v[156:159], v[8:11], 0
    ds_read_b128 v[196:199], v4 offset:2048
    v_mfma_f32_16x16x32_bf16 v[220:223], v[160:163], v[8:11], 0
    ds_read_b128 v[200:203], v4 offset:3072
    v_mfma_f32_16x16x32_bf16 v[224:227], v[164:167], v[8:11], 0
    ds_read_b128 v[204:207], v4 offset:4096
    s_waitcnt vmcnt(5) lgkmcnt(5)
    v_mfma_f32_16x16x32_bf16 v[208:211], v[168:171], v[12:15], v[208:211]
    ds_read_b128 v[148:151], v4 offset:4608
    buffer_load_dwordx4 v[36:39], v142, s[20:23], s55 offen offset:1024 sc1
    v_mfma_f32_16x16x32_bf16 v[212:215], v[172:175], v[12:15], v[212:215]
    ds_read_b128 v[152:155], v4 offset:5632
    v_mfma_f32_16x16x32_bf16 v[216:219], v[176:179], v[12:15], v[216:219]
    ds_read_b128 v[156:159], v4 offset:6656
    v_mfma_f32_16x16x32_bf16 v[220:223], v[180:183], v[12:15], v[220:223]
    ds_read_b128 v[160:163], v4 offset:7680
    v_mfma_f32_16x16x32_bf16 v[224:227], v[184:187], v[12:15], v[224:227]
    ds_read_b128 v[164:167], v4 offset:8704
    s_waitcnt vmcnt(5) lgkmcnt(5)
    v_mfma_f32_16x16x32_bf16 v[208:211], v[188:191], v[16:19], v[208:211]
    v_add_u32 v4, s62, v2
    ds_read_b128 v[168:171], v4 offset:0
    buffer_load_dwordx4 v[40:43], v142, s[20:23], s56 offen offset:0 sc1
    v_mfma_f32_16x16x32_bf16 v[212:215], v[192:195], v[16:19], v[212:215]
    ds_read_b128 v[172:175], v4 offset:1024
    v_mfma_f32_16x16x32_bf16 v[216:219], v[196:199], v[16:19], v[216:219]
    ds_read_b128 v[176:179], v4 offset:2048
    v_mfma_f32_16x16x32_bf16 v[220:223], v[200:203], v[16:19], v[220:223]
    ds_read_b128 v[180:183], v4 offset:3072
    v_mfma_f32_16x16x32_bf16 v[224:227], v[204:207], v[16:19], v[224:227]
    ds_read_b128 v[184:187], v4 offset:4096
    s_waitcnt vmcnt(5) lgkmcnt(5)
    v_mfma_f32_16x16x32_bf16 v[208:211], v[148:151], v[20:23], v[208:211]
    ds_read_b128 v[188:191], v4 offset:4608
    buffer_load_dwordx4 v[44:47], v142, s[20:23], s56 offen offset:1024 sc1
    v_mfma_f32_16x16x32_bf16 v[212:215], v[152:155], v[20:23], v[212:215]
    ds_read_b128 v[192:195], v4 offset:5632
    v_mfma_f32_16x16x32_bf16 v[216:219], v[156:159], v[20:23], v[216:219]
    ds_read_b128 v[196:199], v4 offset:6656
    v_mfma_f32_16x16x32_bf16 v[220:223], v[160:163], v[20:23], v[220:223]
    ds_read_b128 v[200:203], v4 offset:7680
    v_mfma_f32_16x16x32_bf16 v[224:227], v[164:167], v[20:23], v[224:227]
    ds_read_b128 v[204:207], v4 offset:8704
    s_waitcnt vmcnt(5) lgkmcnt(5)
    v_mfma_f32_16x16x32_bf16 v[208:211], v[168:171], v[24:27], v[208:211]
    v_add_u32 v4, s63, v2
    ds_read_b128 v[148:151], v4 offset:0
    buffer_load_dwordx4 v[48:51], v142, s[20:23], s57 offen offset:0 sc1
    v_mfma_f32_16x16x32_bf16 v[212:215], v[172:175], v[24:27], v[212:215]
    ds_read_b128 v[152:155], v4 offset:1024
    v_mfma_f32_16x16x32_bf16 v[216:219], v[176:179], v[24:27], v[216:219]
    ds_read_b128 v[156:159], v4 offset:2048
    v_mfma_f32_16x16x32_bf16 v[220:223], v[180:183], v[24:27], v[220:223]
    ds_read_b128 v[160:163], v4 offset:3072
    v_mfma_f32_16x16x32_bf16 v[224:227], v[184:187], v[24:27], v[224:227]
    ds_read_b128 v[164:167], v4 offset:4096
    s_waitcnt vmcnt(5) lgkmcnt(5)
    v_mfma_f32_16x16x32_bf16 v[208:211], v[188:191], v[28:31], v[208:211]
    ds_read_b128 v[168:171], v4 offset:4608
    buffer_load_dwordx4 v[52:55], v142, s[20:23], s57 offen offset:1024 sc1
    v_mfma_f32_16x16x32_bf16 v[212:215], v[192:195], v[28:31], v[212:215]
    ds_read_b128 v[172:175], v4 offset:5632
    v_mfma_f32_16x16x32_bf16 v[216:219], v[196:199], v[28:31], v[216:219]
    ds_read_b128 v[176:179], v4 offset:6656
    v_mfma_f32_16x16x32_bf16 v[220:223], v[200:203], v[28:31], v[220:223]
    ds_read_b128 v[180:183], v4 offset:7680
    v_mfma_f32_16x16x32_bf16 v[224:227], v[204:207], v[28:31], v[224:227]
    ds_read_b128 v[184:187], v4 offset:8704
    s_waitcnt vmcnt(5) lgkmcnt(5)
    v_mfma_f32_16x16x32_bf16 v[208:211], v[148:151], v[32:35], v[208:211]
    v_add_u32 v4, s64, v2
    ds_read_b128 v[188:191], v4 offset:0
    buffer_load_dwordx4 v[56:59], v142, s[20:23], s58 offen offset:0 sc1
    v_mfma_f32_16x16x32_bf16 v[212:215], v[152:155], v[32:35], v[212:215]
    ds_read_b128 v[192:195], v4 offset:1024
    v_mfma_f32_16x16x32_bf16 v[216:219], v[156:159], v[32:35], v[216:219]
    ds_read_b128 v[196:199], v4 offset:2048
    v_mfma_f32_16x16x32_bf16 v[220:223], v[160:163], v[32:35], v[220:223]
    ds_read_b128 v[200:203], v4 offset:3072
    v_mfma_f32_16x16x32_bf16 v[224:227], v[164:167], v[32:35], v[224:227]
    ds_read_b128 v[204:207], v4 offset:4096
    s_waitcnt vmcnt(5) lgkmcnt(5)
    v_mfma_f32_16x16x32_bf16 v[208:211], v[168:171], v[36:39], v[208:211]
    ds_read_b128 v[148:151], v4 offset:4608
    buffer_load_dwordx4 v[60:63], v142, s[20:23], s58 offen offset:1024 sc1
    v_mfma_f32_16x16x32_bf16 v[212:215], v[172:175], v[36:39], v[212:215]
    ds_read_b128 v[152:155], v4 offset:5632
    v_mfma_f32_16x16x32_bf16 v[216:219], v[176:179], v[36:39], v[216:219]
    ds_read_b128 v[156:159], v4 offset:6656
    v_mfma_f32_16x16x32_bf16 v[220:223], v[180:183], v[36:39], v[220:223]
    ds_read_b128 v[160:163], v4 offset:7680
    v_mfma_f32_16x16x32_bf16 v[224:227], v[184:187], v[36:39], v[224:227]
    ds_read_b128 v[164:167], v4 offset:8704
    s_waitcnt vmcnt(5) lgkmcnt(5)
    v_mfma_f32_16x16x32_bf16 v[208:211], v[188:191], v[40:43], v[208:211]
    v_add_u32 v4, s65, v2
    ds_read_b128 v[168:171], v4 offset:0
    buffer_load_dwordx4 v[64:67], v142, s[20:23], s59 offen offset:0 sc1
    v_mfma_f32_16x16x32_bf16 v[212:215], v[192:195], v[40:43], v[212:215]
    ds_read_b128 v[172:175], v4 offset:1024
    v_mfma_f32_16x16x32_bf16 v[216:219], v[196:199], v[40:43], v[216:219]
    ds_read_b128 v[176:179], v4 offset:2048
    v_mfma_f32_16x16x32_bf16 v[220:223], v[200:203], v[40:43], v[220:223]
    ds_read_b128 v[180:183], v4 offset:3072
    v_mfma_f32_16x16x32_bf16 v[224:227], v[204:207], v[40:43], v[224:227]
    ds_read_b128 v[184:187], v4 offset:4096
    s_waitcnt vmcnt(5) lgkmcnt(5)
    v_mfma_f32_16x16x32_bf16 v[208:211], v[148:151], v[44:47], v[208:211]
    ds_read_b128 v[188:191], v4 offset:4608
    buffer_load_dwordx4 v[68:71], v142, s[20:23], s59 offen offset:1024 sc1
    v_mfma_f32_16x16x32_bf16 v[212:215], v[152:155], v[44:47], v[212:215]
    ds_read_b128 v[192:195], v4 offset:5632
    v_mfma_f32_16x16x32_bf16 v[216:219], v[156:159], v[44:47], v[216:219]
    ds_read_b128 v[196:199], v4 offset:6656
    v_mfma_f32_16x16x32_bf16 v[220:223], v[160:163], v[44:47], v[220:223]
    ds_read_b128 v[200:203], v4 offset:7680
    v_mfma_f32_16x16x32_bf16 v[224:227], v[164:167], v[44:47], v[224:227]
    ds_read_b128 v[204:207], v4 offset:8704
    s_waitcnt vmcnt(5) lgkmcnt(5)
    v_mfma_f32_16x16x32_bf16 v[208:211], v[168:171], v[48:51], v[208:211]
    v_add_u32 v4, s66, v2
    ds_read_b128 v[148:151], v4 offset:0
    s_add_u32 s17, s15, 0
    buffer_load_dword v72, v1, s[20:23], s17 offen sc1
    v_mfma_f32_16x16x32_bf16 v[212:215], v[172:175], v[48:51], v[212:215]
    ds_read_b128 v[152:155], v4 offset:1024
    s_add_u32 s17, s15, 8192
    buffer_load_dword v73, v1, s[20:23], s17 offen sc1
    v_mfma_f32_16x16x32_bf16 v[216:219], v[176:179], v[48:51], v[216:219]
    ds_read_b128 v[156:159], v4 offset:2048
    s_add_u32 s17, s15, 16384
    buffer_load_dword v74, v1, s[20:23], s17 offen sc1
    v_mfma_f32_16x16x32_bf16 v[220:223], v[180:183], v[48:51], v[220:223]
    ds_read_b128 v[160:163], v4 offset:3072
    s_add_u32 s17, s15, 24576
    buffer_load_dword v75, v1, s[20:23], s17 offen sc1
    v_mfma_f32_16x16x32_bf16 v[224:227], v[184:187], v[48:51], v[224:227]
    ds_read_b128 v[164:167], v4 offset:4096
    s_waitcnt vmcnt(8) lgkmcnt(5)
    v_mfma_f32_16x16x32_bf16 v[208:211], v[188:191], v[52:55], v[208:211]
    ds_read_b128 v[168:171], v4 offset:4608
    s_add_u32 s17, s15, 131072
    buffer_load_dword v76, v1, s[20:23], s17 offen sc1
    v_mfma_f32_16x16x32_bf16 v[212:215], v[192:195], v[52:55], v[212:215]
    ds_read_b128 v[172:175], v4 offset:5632
    s_add_u32 s17, s15, 139264
    buffer_load_dword v77, v1, s[20:23], s17 offen sc1
    v_mfma_f32_16x16x32_bf16 v[216:219], v[196:199], v[52:55], v[216:219]
    ds_read_b128 v[176:179], v4 offset:6656
    s_add_u32 s17, s15, 147456
    buffer_load_dword v78, v1, s[20:23], s17 offen sc1
    v_mfma_f32_16x16x32_bf16 v[220:223], v[200:203], v[52:55], v[220:223]
    ds_read_b128 v[180:183], v4 offset:7680
    s_add_u32 s17, s15, 155648
    buffer_load_dword v79, v1, s[20:23], s17 offen sc1
    v_mfma_f32_16x16x32_bf16 v[224:227], v[204:207], v[52:55], v[224:227]
    ds_read_b128 v[184:187], v4 offset:8704
    s_waitcnt vmcnt(11) lgkmcnt(5)
    v_mfma_f32_16x16x32_bf16 v[208:211], v[148:151], v[56:59], v[208:211]
    v_add_u32 v4, s67, v2
    ds_read_b128 v[188:191], v4 offset:0
    v_mfma_f32_16x16x32_bf16 v[212:215], v[152:155], v[56:59], v[212:215]
    ds_read_b128 v[192:195], v4 offset:1024
    v_mfma_f32_16x16x32_bf16 v[216:219], v[156:159], v[56:59], v[216:219]
    ds_read_b128 v[196:199], v4 offset:2048
    v_mfma_f32_16x16x32_bf16 v[220:223], v[160:163], v[56:59], v[220:223]
    ds_read_b128 v[200:203], v4 offset:3072
    v_mfma_f32_16x16x32_bf16 v[224:227], v[164:167], v[56:59], v[224:227]
    ds_read_b128 v[204:207], v4 offset:4096
    s_waitcnt vmcnt(10) lgkmcnt(5)
    v_mfma_f32_16x16x32_bf16 v[208:211], v[168:171], v[60:63], v[208:211]
    ds_read_b128 v[148:151], v4 offset:4608
    v_mfma_f32_16x16x32_bf16 v[212:215], v[172:175], v[60:63], v[212:215]
    ds_read_b128 v[152:155], v4 offset:5632
    v_mfma_f32_16x16x32_bf16 v[216:219], v[176:179], v[60:63], v[216:219]
    ds_read_b128 v[156:159], v4 offset:6656
    v_mfma_f32_16x16x32_bf16 v[220:223], v[180:183], v[60:63], v[220:223]
    ds_read_b128 v[160:163], v4 offset:7680
    v_mfma_f32_16x16x32_bf16 v[224:227], v[184:187], v[60:63], v[224:227]
    ds_read_b128 v[164:167], v4 offset:8704
    s_waitcnt vmcnt(9) lgkmcnt(5)
    v_mfma_f32_16x16x32_bf16 v[208:211], v[188:191], v[64:67], v[208:211]
    v_add_u32 v4, 73728, v2
    ds_read_b128 v[168:171], v4 offset:0
    v_mfma_f32_16x16x32_bf16 v[212:215], v[192:195], v[64:67], v[212:215]
    ds_read_b128 v[172:175], v4 offset:1024
    v_mfma_f32_16x16x32_bf16 v[216:219], v[196:199], v[64:67], v[216:219]
    ds_read_b128 v[176:179], v4 offset:2048
    v_mfma_f32_16x16x32_bf16 v[220:223], v[200:203], v[64:67], v[220:223]
    ds_read_b128 v[180:183], v4 offset:3072
    v_mfma_f32_16x16x32_bf16 v[224:227], v[204:207], v[64:67], v[224:227]
    ds_read_b128 v[184:187], v4 offset:4096
    s_waitcnt vmcnt(8) lgkmcnt(5)
    v_mfma_f32_16x16x32_bf16 v[208:211], v[148:151], v[68:71], v[208:211]
    v_mfma_f32_16x16x32_bf16 v[212:215], v[152:155], v[68:71], v[212:215]
    v_mfma_f32_16x16x32_bf16 v[216:219], v[156:159], v[68:71], v[216:219]
    v_mfma_f32_16x16x32_bf16 v[220:223], v[160:163], v[68:71], v[220:223]
    v_mfma_f32_16x16x32_bf16 v[224:227], v[164:167], v[68:71], v[224:227]
    s_waitcnt lgkmcnt(0)
    s_barrier
    s_waitcnt vmcnt(4) lgkmcnt(0)
    v_mfma_f32_16x16x32_bf16 v[208:211], v[168:171], v[72:75], v[208:211]
    v_mfma_f32_16x16x32_bf16 v[212:215], v[172:175], v[72:75], v[212:215]
    v_mfma_f32_16x16x32_bf16 v[216:219], v[176:179], v[72:75], v[216:219]
    v_mfma_f32_16x16x32_bf16 v[220:223], v[180:183], v[72:75], v[220:223]
    v_mfma_f32_16x16x32_bf16 v[224:227], v[184:187], v[72:75], v[224:227]
    s_waitcnt vmcnt(0) lgkmcnt(0)
    v_mfma_f32_16x16x32_bf16 v[208:211], v[228:231], v[76:79], v[208:211]
    v_mfma_f32_16x16x32_bf16 v[212:215], v[232:235], v[76:79], v[212:215]
    v_mfma_f32_16x16x32_bf16 v[216:219], v[236:239], v[76:79], v[216:219]
    v_mfma_f32_16x16x32_bf16 v[220:223], v[240:243], v[76:79], v[220:223]
    v_mfma_f32_16x16x32_bf16 v[224:227], v[244:247], v[76:79], v[224:227]
    s_mul_i32 s16, s47, 5120
    v_add_u32 v4, s16, v142
    s_nop 0
    s_cmp_eq_u32 s48, 0
    s_cbranch_scc1 K2_RED0
    s_nop 3
    ds_write_b128 v4, v[208:211] offset:0
    ds_write_b128 v4, v[212:215] offset:1024
    ds_write_b128 v4, v[216:219] offset:2048
    ds_write_b128 v4, v[220:223] offset:3072
    ds_write_b128 v4, v[224:227] offset:4096
    s_waitcnt lgkmcnt(0)
    s_barrier
    s_branch K2_DONE
K2_RED0:
    s_barrier
    ds_read_b128 v[20:23], v4 offset:0
    ds_read_b128 v[24:27], v4 offset:1024
    ds_read_b128 v[28:31], v4 offset:2048
    ds_read_b128 v[32:35], v4 offset:3072
    ds_read_b128 v[36:39], v4 offset:4096
    s_waitcnt lgkmcnt(4)
    v_add_f32 v208, v208, v20
    v_add_f32 v209, v209, v21
    v_add_f32 v210, v210, v22
    v_add_f32 v211, v211, v23
    v_cvt_pk_bf16_f32 v8, v208, v209
    v_cvt_pk_bf16_f32 v9, v210, v211
    s_waitcnt lgkmcnt(3)
    v_add_f32 v212, v212, v24
    v_add_f32 v213, v213, v25
    v_add_f32 v214, v214, v26
    v_add_f32 v215, v215, v27
    v_cvt_pk_bf16_f32 v10, v212, v213
    v_cvt_pk_bf16_f32 v11, v214, v215
    s_waitcnt lgkmcnt(2)
    v_add_f32 v216, v216, v28
    v_add_f32 v217, v217, v29
    v_add_f32 v218, v218, v30
    v_add_f32 v219, v219, v31
    v_cvt_pk_bf16_f32 v12, v216, v217
    v_cvt_pk_bf16_f32 v13, v218, v219
    s_waitcnt lgkmcnt(1)
    v_add_f32 v220, v220, v32
    v_add_f32 v221, v221, v33
    v_add_f32 v222, v222, v34
    v_add_f32 v223, v223, v35
    v_cvt_pk_bf16_f32 v14, v220, v221
    v_cvt_pk_bf16_f32 v15, v222, v223
    s_waitcnt lgkmcnt(0)
    v_add_f32 v224, v224, v36
    v_add_f32 v225, v225, v37
    v_add_f32 v226, v226, v38
    v_add_f32 v227, v227, v39
    v_cvt_pk_bf16_f32 v16, v224, v225
    v_cvt_pk_bf16_f32 v17, v226, v227
    v_permlane16_swap_b32 v8, v10
    v_permlane16_swap_b32 v9, v11
    buffer_store_dwordx4 v[8:11], v7, s[24:27], s14 offen offset:0
    v_permlane16_swap_b32 v12, v14
    v_permlane16_swap_b32 v13, v15
    buffer_store_dwordx4 v[12:15], v7, s[24:27], s14 offen offset:64
    buffer_store_dwordx2 v[16:17], v6, s[24:27], s14 offen offset:128
K2_DONE:
K2_END:
    s_endpgm
K2_SYNC1:
    s_cmp_eq_u32 s18, 4
    s_cbranch_scc1 K2_SYNC1C
    s_add_u32 s40, s18, 1
    s_cmp_eq_u32 s18, 2
    s_cselect_b32 s40, 4, s40
    s_mov_b32 s16, 0
K2_EVS:
    ds_read_b32 v1, v248 offset:4
    s_add_u32 s16, s16, 1
    s_waitcnt lgkmcnt(0)
    v_readfirstlane_b32 s17, v1
    s_cmp_ge_u32 s16, 0x400000
    s_cbranch_scc1 K2_EVSD
    s_cmp_ge_u32 s17, 4
    s_cbranch_scc1 K2_EVSD
    s_sleep 1
    s_branch K2_EVS
K2_EVSD:
    v_add_u32 v248, 4, v248
    s_branch K2_SYNC_RET
K2_SYNC1C:
    s_mov_b32 s17, 0
    v_mov_b32 v1, 0
K2_WPOLL:
    buffer_load_dword v128, v1, s[48:51], 0 offen sc1
    buffer_load_dword v129, v1, s[48:51], 0 offen offset:128 sc1
    s_add_u32 s17, s17, 1
    s_waitcnt vmcnt(0)
    v_readfirstlane_b32 s30, v128
    v_readfirstlane_b32 s71, v129
    s_cmp_ge_u32 s17, 0x40000
    s_cbranch_scc1 K2_WRDY
    s_cmp_ge_u32 s30, 256
    s_cbranch_scc1 K2_WRDY
    s_sleep 16
    s_branch K2_WPOLL
K2_WRDY:
    s_lshl_b32 s16, s14, 7
    s_add_u32 s16, s16, 9961472
    v_and_b32 v1, 0x7c, v138
    buffer_load_dword v2, v1, s[20:23], s16 offen sc1
    buffer_load_dword v3, v1, s[20:23], s16 offen offset:128 sc1
    s_and_b32 s45, s2, 7
    s_lshl_b32 s45, s45, 2
    s_bfe_u32 s46, s2, 0x20003
    s_add_u32 s45, s45, s46
    s_lshr_b32 s46, s2, 5
    s_mul_i32 s30, s46, 165888
    s_add_u32 s30, s30, 10485760
    s_add_u32 s16, s30, s13
    buffer_load_dwordx4 v[148:151], v142, s[20:23], s16 offen sc1
    s_add_u32 s16, s16, 8192
    buffer_load_dwordx4 v[152:155], v142, s[20:23], s16 offen sc1
    s_add_u32 s16, s16, 8192
    buffer_load_dwordx4 v[156:159], v142, s[20:23], s16 offen sc1
    s_add_u32 s16, s16, 8192
    buffer_load_dwordx4 v[160:163], v142, s[20:23], s16 offen sc1
    s_add_u32 s16, s16, 8192
    buffer_load_dwordx4 v[164:167], v142, s[20:23], s16 offen sc1
    s_add_u32 s16, s16, 8192
    buffer_load_dwordx4 v[168:171], v142, s[20:23], s16 offen sc1
    s_add_u32 s16, s16, 8192
    buffer_load_dwordx4 v[172:175], v142, s[20:23], s16 offen sc1
    s_add_u32 s16, s16, 8192
    buffer_load_dwordx4 v[176:179], v142, s[20:23], s16 offen sc1
    s_add_u32 s16, s16, 8192
    buffer_load_dwordx4 v[180:183], v142, s[20:23], s16 offen sc1
    s_add_u32 s16, s16, 8192
    buffer_load_dwordx4 v[184:187], v142, s[20:23], s16 offen sc1
    s_add_u32 s16, s16, 8192
    buffer_load_dwordx4 v[188:191], v142, s[20:23], s16 offen sc1
    s_add_u32 s16, s16, 8192
    buffer_load_dwordx4 v[192:195], v142, s[20:23], s16 offen sc1
    s_add_u32 s16, s16, 8192
    buffer_load_dwordx4 v[196:199], v142, s[20:23], s16 offen sc1
    s_add_u32 s16, s16, 8192
    buffer_load_dwordx4 v[200:203], v142, s[20:23], s16 offen sc1
    s_add_u32 s16, s16, 8192
    buffer_load_dwordx4 v[204:207], v142, s[20:23], s16 offen sc1
    s_add_u32 s16, s16, 8192
    buffer_load_dwordx4 v[208:211], v142, s[20:23], s16 offen sc1
    s_add_u32 s16, s16, 8192
    buffer_load_dwordx4 v[212:215], v142, s[20:23], s16 offen sc1
    s_add_u32 s16, s16, 8192
    buffer_load_dwordx4 v[216:219], v142, s[20:23], s16 offen sc1
    s_add_u32 s16, s16, 8192
    buffer_load_dwordx4 v[220:223], v142, s[20:23], s16 offen sc1
    s_add_u32 s16, s16, 8192
    buffer_load_dwordx4 v[224:227], v142, s[20:23], s16 offen sc1
    s_add_u32 s16, s16, 8192
    v_lshrrev_b32 v1, 4, v0
    v_lshlrev_b32 v1, 7, v1
    v_and_b32 v128, 7, v0
    v_lshl_add_u32 v1, v128, 4, v1
    v_bfe_u32 v128, v0, 3, 1
    v_lshl_add_u32 v1, v128, 9, v1
    s_lshr_b32 s16, s3, 2
    s_mul_i32 s16, s16, 82944
    s_add_u32 s16, s16, s30
    s_add_u32 s16, s16, 78336
    buffer_load_dwordx4 v[228:231], v1, s[20:23], s16 offen offset:0 sc1
    buffer_load_dwordx4 v[232:235], v1, s[20:23], s16 offen offset:1024 sc1
    buffer_load_dwordx4 v[236:239], v1, s[20:23], s16 offen offset:2048 sc1
    buffer_load_dwordx4 v[240:243], v1, s[20:23], s16 offen offset:3072 sc1
    s_add_u32 s16, s16, 4096
    buffer_load_dwordx4 v[244:247], v1, s[20:23], s16 offen sc1
    s_branch K2_SYNC_RET
K2_SLOW:
    s_waitcnt vmcnt(0)
    v_mov_b32 v17, 0
    v_mov_b32 v134, 0xff800000
    v_mov_b32 v135, 0xff800000
    v_subrev_u32 v4, 73728, v4
    v_subrev_u32 v5, 73728, v5
    v_subrev_u32 v6, 77824, v6
    s_mov_b32 s18, 0
K2_SLOW_A:
    ds_read_b32 v18, v5 offset:0
    ds_read2st64_b64 v[20:23], v4 offset0:0 offset1:1
    s_waitcnt lgkmcnt(0)
    v_mfma_f32_32x32x4_2b_bf16 v[32:63], v[18:19], v[16:17], 0
    s_nop 15
    s_nop 3
    v_mfma_f32_32x32x16_bf16 v[32:47], v[20:23], v[8:11], v[32:47]
    v_mfma_f32_32x32x16_bf16 v[48:63], v[20:23], v[12:15], v[48:63]
    s_nop 15
    v_max3_f32 v134, v134, v32, v33
    v_max3_f32 v134, v134, v34, v35
    v_max3_f32 v134, v134, v36, v37
    v_max3_f32 v134, v134, v38, v39
    v_max3_f32 v134, v134, v40, v41
    v_max3_f32 v134, v134, v42, v43
    v_max3_f32 v134, v134, v44, v45
    v_max3_f32 v134, v134, v46, v47
    v_max3_f32 v135, v135, v48, v49
    v_max3_f32 v135, v135, v50, v51
    v_max3_f32 v135, v135, v52, v53
    v_max3_f32 v135, v135, v54, v55
    v_max3_f32 v135, v135, v56, v57
    v_max3_f32 v135, v135, v58, v59
    v_max3_f32 v135, v135, v60, v61
    v_max3_f32 v135, v135, v62, v63
    s_add_u32 s18, s18, 1
    s_and_b32 s16, s18, 7
    s_cmp_eq_u32 s16, 0
    s_mov_b32 s17, 1024
    s_cselect_b32 s16, 2048, s17
    v_add_u32 v4, s16, v4
    s_mov_b32 s17, 128
    s_cselect_b32 s16, 8320, s17
    v_add_u32 v5, s16, v5
    v_add_u32 v6, 1216, v6
    s_cmp_lt_u32 s18, 64
    s_cbranch_scc1 K2_SLOW_A
    v_mov_b32 v133, v134
    s_nop 1
    v_permlane32_swap_b32 v134, v133
    s_nop 1
    v_max_f32 v134, v134, v133
    v_mov_b32 v133, v135
    s_nop 1
    v_permlane32_swap_b32 v135, v133
    s_nop 1
    v_max_f32 v135, v135, v133
    v_mov_b32 v96, 0
    v_mov_b32 v97, 0
    v_mov_b32 v98, 0
    v_mov_b32 v99, 0
    v_mov_b32 v100, 0
    v_mov_b32 v101, 0
    v_mov_b32 v102, 0
    v_mov_b32 v103, 0
    v_mov_b32 v104, 0
    v_mov_b32 v105, 0
    v_mov_b32 v106, 0
    v_mov_b32 v107, 0
    v_mov_b32 v108, 0
    v_mov_b32 v109, 0
    v_mov_b32 v110, 0
    v_mov_b32 v111, 0
    v_mov_b32 v112, 0
    v_mov_b32 v113, 0
    v_mov_b32 v114, 0
    v_mov_b32 v115, 0
    v_mov_b32 v116, 0
    v_mov_b32 v117, 0
    v_mov_b32 v118, 0
    v_mov_b32 v119, 0
    v_mov_b32 v120, 0
    v_mov_b32 v121, 0
    v_mov_b32 v122, 0
    v_mov_b32 v123, 0
    v_mov_b32 v124, 0
    v_mov_b32 v125, 0
    v_mov_b32 v126, 0
    v_mov_b32 v127, 0
    v_subrev_u32 v4, 73728, v4
    v_subrev_u32 v5, 73728, v5
    v_subrev_u32 v6, 77824, v6
    s_mov_b32 s18, 0
K2_SLOW_B:
    ds_read_b128 v[24:27], v6 offset:0
    ds_read_b128 v[28:31], v6 offset:608
    ds_read_b32 v18, v5 offset:0
    ds_read2st64_b64 v[20:23], v4 offset0:0 offset1:1
    s_waitcnt lgkmcnt(0)
    v_mfma_f32_32x32x4_2b_bf16 v[32:63], v[18:19], v[16:17], 0
    s_nop 15
    s_nop 3
    v_mfma_f32_32x32x16_bf16 v[32:47], v[20:23], v[8:11], v[32:47]
    v_mfma_f32_32x32x16_bf16 v[48:63], v[20:23], v[12:15], v[48:63]
    s_nop 15
    v_sub_f32 v32, v32, v134
    v_sub_f32 v33, v33, v134
    v_sub_f32 v34, v34, v134
    v_sub_f32 v35, v35, v134
    v_sub_f32 v36, v36, v134
    v_sub_f32 v37, v37, v134
    v_sub_f32 v38, v38, v134
    v_sub_f32 v39, v39, v134
    v_sub_f32 v40, v40, v134
    v_sub_f32 v41, v41, v134
    v_sub_f32 v42, v42, v134
    v_sub_f32 v43, v43, v134
    v_sub_f32 v44, v44, v134
    v_sub_f32 v45, v45, v134
    v_sub_f32 v46, v46, v134
    v_sub_f32 v47, v47, v134
    v_sub_f32 v48, v48, v135
    v_sub_f32 v49, v49, v135
    v_sub_f32 v50, v50, v135
    v_sub_f32 v51, v51, v135
    v_sub_f32 v52, v52, v135
    v_sub_f32 v53, v53, v135
    v_sub_f32 v54, v54, v135
    v_sub_f32 v55, v55, v135
    v_sub_f32 v56, v56, v135
    v_sub_f32 v57, v57, v135
    v_sub_f32 v58, v58, v135
    v_sub_f32 v59, v59, v135
    v_sub_f32 v60, v60, v135
    v_sub_f32 v61, v61, v135
    v_sub_f32 v62, v62, v135
    v_sub_f32 v63, v63, v135
    v_exp_f32 v32, v32
    v_exp_f32 v33, v33
    v_exp_f32 v34, v34
    v_exp_f32 v35, v35
    v_exp_f32 v36, v36
    v_exp_f32 v37, v37
    v_exp_f32 v38, v38
    v_exp_f32 v39, v39
    v_exp_f32 v40, v40
    v_exp_f32 v41, v41
    v_exp_f32 v42, v42
    v_exp_f32 v43, v43
    v_exp_f32 v44, v44
    v_exp_f32 v45, v45
    v_exp_f32 v46, v46
    v_exp_f32 v47, v47
    v_exp_f32 v48, v48
    v_exp_f32 v49, v49
    v_exp_f32 v50, v50
    v_exp_f32 v51, v51
    v_exp_f32 v52, v52
    v_exp_f32 v53, v53
    v_exp_f32 v54, v54
    v_exp_f32 v55, v55
    v_exp_f32 v56, v56
    v_exp_f32 v57, v57
    v_exp_f32 v58, v58
    v_exp_f32 v59, v59
    v_exp_f32 v60, v60
    v_exp_f32 v61, v61
    v_exp_f32 v62, v62
    v_exp_f32 v63, v63
    s_nop 1
    v_smfmac_f32_32x32x32_bf16 v[96:111], v[24:27], v[32:39], v7
    v_smfmac_f32_32x32x32_bf16 v[96:111], v[28:31], v[40:47], v7
    v_smfmac_f32_32x32x32_bf16 v[112:127], v[24:27], v[48:55], v7
    v_smfmac_f32_32x32x32_bf16 v[112:127], v[28:31], v[56:63], v7
    s_add_u32 s18, s18, 1
    s_and_b32 s16, s18, 7
    s_cmp_eq_u32 s16, 0
    s_mov_b32 s17, 1024
    s_cselect_b32 s16, 2048, s17
    v_add_u32 v4, s16, v4
    s_mov_b32 s17, 128
    s_cselect_b32 s16, 8320, s17
    v_add_u32 v5, s16, v5
    v_add_u32 v6, 1216, v6
    s_cmp_lt_u32 s18, 64
    s_cbranch_scc1 K2_SLOW_B
    s_mov_b32 s19, 1
    s_nop 15
    s_branch K2_FIN
CODE_END:
.section .rodata,"a"
.p2align 6
.amdhsa_kernel gated_mix__softmax_full_mha__grouped_kv_mqa__prompt_kernel
  .amdhsa_next_free_vgpr 256
  .amdhsa_next_free_sgpr 96
  .amdhsa_accum_offset 256
  .amdhsa_group_segment_fixed_size 0
  .amdhsa_kernarg_size 96
  .amdhsa_user_sgpr_count 2
  .amdhsa_user_sgpr_kernarg_segment_ptr 1
  .amdhsa_system_sgpr_workgroup_id_x 1
.end_amdhsa_kernel
```
